```python
import torch

def _softmax(x, axis=-1):
    return torch.softmax(x, dim=axis)
def _gelu(x):
    return torch.nn.functional.gelu(x, approximate="tanh")
def _silu(x):
    return torch.nn.functional.silu(x)
def _sigmoid(x):
    return torch.sigmoid(x)
def _layernorm(x, axis=-1, eps=1e-5):
    m = x.mean(dim=axis, keepdim=True)
    v = x.var(dim=axis, keepdim=True, unbiased=False)
    return (x - m) / torch.sqrt(v + eps)
def _scatter_add(tgt, idx, src, axis=0):
    return tgt.clone().index_add_(axis, idx, src)
def _segment_sum(src, seg, n):
    out = torch.zeros((n,) + src.shape[1:], dtype=src.dtype)
    return out.index_add_(0, seg, src)
def _pad(x, pw):
    flat = tuple(v for pair in reversed(pw) for v in pair)
    return torch.nn.functional.pad(x, flat)

kernel_name = 'sequential_preLN__ssm_conv_s4__dense_activation_relu__prompt'

def setup_inputs():

    _w = (lambda a: (lambda t: t.to(torch.bfloat16) if t.is_floating_point() else t)(torch.as_tensor(a)))
    def _A_setup():
        B, L, D, N = 1, 2048, 448, 256
        A_re = -(lambda _x: torch.exp(torch.as_tensor(_x)))((lambda *s: torch.randn(*s, dtype=torch.bfloat16) * 3.2)(D, N))
        A_im = torch.pi * (lambda *s: torch.randn(*s, dtype=torch.bfloat16) * 0.05)(D, N)
        B_re = (lambda *s: torch.randn(*s, dtype=torch.bfloat16) * 0.05)(D, N)
        B_im = (lambda *s: torch.randn(*s, dtype=torch.bfloat16) * 0.05)(D, N)
        C_re = (lambda *s: torch.randn(*s, dtype=torch.bfloat16) * 0.05)(D, N)
        C_im = (lambda *s: torch.randn(*s, dtype=torch.bfloat16) * 0.05)(D, N)
        log_dt = (lambda *s: torch.randn(*s, dtype=torch.bfloat16) * 0.05)(D) * 0.5 - 4.0
        Dskip = (lambda *s: torch.randn(*s, dtype=torch.bfloat16) * 0.05)(D)
        return {
            "u": _w((lambda *s: torch.randn(*s, dtype=torch.bfloat16) * 0.05)(B, L, D)),
            "A_re": _w(A_re),
            "A_im": _w(A_im),
            "B_re": _w(B_re),
            "B_im": _w(B_im),
            "C_re": _w(C_re),
            "C_im": _w(C_im),
            "log_dt": _w(log_dt),
            "Dskip": _w(Dskip),
        }
    _A_in = _A_setup()

    def _B_setup():
        B, S, D, Dff = 1, 2048, 448, 1792
        return {
            "x": _w((lambda *s: torch.randn(*s, dtype=torch.bfloat16) * 0.05)(B, S, D)),
            "w1": _w((lambda *s: torch.randn(*s, dtype=torch.bfloat16) * 0.05)(D, Dff)),
            "w2": _w((lambda *s: torch.randn(*s, dtype=torch.bfloat16) * 0.05)(Dff, D)),
        }
    _B_in = _B_setup()

    return {
        "A_u": _A_in["u"],
        "A_A_re": _A_in["A_re"],
        "A_A_im": _A_in["A_im"],
        "A_B_re": _A_in["B_re"],
        "A_B_im": _A_in["B_im"],
        "A_C_re": _A_in["C_re"],
        "A_C_im": _A_in["C_im"],
        "A_log_dt": _A_in["log_dt"],
        "A_Dskip": _A_in["Dskip"],
        "B_x": _B_in["x"],
        "B_w1": _B_in["w1"],
        "B_w2": _B_in["w2"],
    }

def reference(A_u, A_A_re, A_A_im, A_B_re, A_B_im, A_C_re, A_C_im, A_log_dt, A_Dskip, B_x, B_w1, B_w2):
    def _A_ref(u, A_re, A_im, B_re, B_im, C_re, C_im, log_dt, Dskip):
        Bsz, L, D = u.shape
        dt = torch.exp(log_dt)[:, None]
        A = A_re + 1j * A_im
        Bc = B_re + 1j * B_im
        Cc = C_re + 1j * C_im
        logdA = dt * A
        dB = dt * Bc
        l = (lambda x, dt: x.to(dt))(torch.arange(L), A_re.dtype)
        P = torch.exp(logdA[:, :, None] * l[None, None, :])
        K = torch.einsum("dn,dnl,dn->dl", Cc, P, dB).real
        L2 = 2 * L
        Kp = _pad(K, ((0, 0), (0, L)))
        up = (lambda x, *d: x.permute(*d))(u, 0, 2, 1)
        up = _pad(up, ((0, 0), (0, 0), (0, L)))
        Kf = (lambda x, axes=(-2,-1): torch.fft.rfft2(x.float(), dim=axes))(Kp[:, None, :], axes=(-2, -1))
        Uf = (lambda x, axes=(-2,-1): torch.fft.rfft2(x.float(), dim=axes))(up[:, :, None, :], axes=(-2, -1))
        Yf = Uf * Kf[None, :, :, :]
        y = (lambda x, s, axes=(-2,-1): torch.fft.irfft2(x, s=s, dim=axes).to(torch.bfloat16))(Yf, (1, L2), axes=(-2, -1))[:, :, 0, :L]
        y = (lambda x, *d: x.permute(*d))(y, 0, 2, 1) + u * Dskip[None, None, :]
        return y

    def _B_ref(x, w1, w2):
        h = torch.einsum("bsd,df->bsf", x, w1)
        zero = torch.zeros_like(h)
        h = torch.maximum(h, zero)
        return torch.einsum("bsf,fd->bsd", h, w2)

    x = A_u
    h = x + _A_ref(_layernorm(x, axis=-1), A_A_re, A_A_im, A_B_re, A_B_im, A_C_re, A_C_im, A_log_dt, A_Dskip)
    h2 = h + _B_ref(_layernorm(h, axis=-1), B_w1, B_w2)
    return h2
```

```asm
; @launch kernel=k12_kernel grid=(256,1,1) block=(512,1,1) lds=157312
; @launch kernel=k34_kernel grid=(256,1,1) block=(512,1,1) lds=139328
.amdgcn_target "amdgcn-amd-amdhsa--gfx950"
.text
.globl k12_kernel
.p2align 8
.type k12_kernel,@function
k12_kernel:
    s_cmp_ge_u32 s2, 256
    s_cbranch_scc1 K12_END
    s_load_dwordx16 s[36:51], s[0:1], 0
    s_load_dwordx8 s[52:59], s[0:1], 64
    s_load_dwordx4 s[60:63], s[0:1], 96
    s_load_dwordx2 s[64:65], s[0:1], 112
    v_lshrrev_b32 v1, 6, v0
    s_nop 0
    v_readfirstlane_b32 s6, v1
    v_and_b32 v2, 63, v0
    s_lshr_b32 s8, s6, 2
    s_and_b32 s9, s6, 3
    s_sub_u32 s4, s2, 32
    s_lshl_b32 s4, s4, 1
    s_mov_b32 s20, 0x3fb8aa3b
    s_mov_b32 s21, 0x32a57060
    s_mov_b32 s22, 0x3f317218
    s_mov_b32 s23, 0x3e22f983
    s_mov_b32 s24, 0xffff0000
    s_mov_b32 s25, 0x07060302
    s_cmp_lt_u32 s2, 32
    s_cbranch_scc1 K12_TR
    s_add_u32 s4, s4, s8
    v_and_b32 v5, 31, v2
    v_lshlrev_b32 v5, 1, v5
    s_lshl_b32 s7, s4, 9
    s_lshl_b32 s10, s9, 7
    s_add_u32 s7, s7, s10
    v_add_u32 v5, s7, v5
    s_lshl_b32 s7, s4, 1
    v_mov_b32 v6, s7
    s_sub_u32 s3, s2, 32
    s_and_b32 s66, s3, 31
    s_lshr_b32 s67, s3, 5
    v_lshrrev_b32 v7, 3, v0
    v_and_b32 v8, 7, v0
    s_lshl_b32 s7, s66, 6
    v_add_u32 v9, s7, v7
    s_movk_i32 s7, 896
    v_mul_lo_u32 v9, v9, s7
    v_lshl_add_u32 v9, v8, 4, v9
    s_lshl_b32 s7, s67, 7
    v_add_u32 v9, s7, v9
    s_movk_i32 s7, 144
    v_mul_lo_u32 v206, v7, s7
    v_lshl_add_u32 v206, v8, 4, v206
    v_add_u32 v206, 148096, v206
    v_mov_b32 v7, 0
    v_mov_b32 v15, 147968
    ds_write_b32 v15, v7
    ds_write_b32 v15, v7 offset:4
    s_waitcnt lgkmcnt(0)
    global_load_dwordx4 v[208:211], v9, s[36:37]
    global_load_ushort v14, v6, s[50:51]
    global_load_ushort v176, v5, s[38:39] offset:0
    global_load_ushort v177, v5, s[40:41] offset:0
    global_load_ushort v178, v5, s[42:43] offset:0
    global_load_ushort v179, v5, s[44:45] offset:0
    global_load_ushort v180, v5, s[46:47] offset:0
    global_load_ushort v181, v5, s[48:49] offset:0
    global_load_ushort v184, v5, s[38:39] offset:64
    global_load_ushort v185, v5, s[40:41] offset:64
    global_load_ushort v186, v5, s[42:43] offset:64
    global_load_ushort v187, v5, s[44:45] offset:64
    global_load_ushort v188, v5, s[46:47] offset:64
    global_load_ushort v189, v5, s[48:49] offset:64
    global_load_ushort v200, v6, s[52:53]
    v_cmp_lt_u32 s[26:27], 31, v2
    v_mov_b32 v8, 1.0
    v_mov_b32 v9, 0x43000000
    v_cndmask_b32 v202, v8, v9, s[26:27]
    v_mov_b32 v8, 0x41000000
    v_mov_b32 v9, 0x44800000
    v_cndmask_b32 v203, v8, v9, s[26:27]
    v_and_b32 v8, 31, v2
    s_movk_i32 s7, 264
    v_mul_lo_u32 v8, v8, s7
    s_mul_i32 s7, s6, 8448
    v_add_u32 v204, s7, v8
    v_lshrrev_b32 v8, 5, v2
    v_lshl_add_u32 v205, v8, 6, v204
    v_and_b32 v3, 15, v2
    v_lshrrev_b32 v4, 4, v2
    v_and_b32 v9, 7, v3
    v_lshrrev_b32 v10, 3, v3
    v_lshl_add_u32 v6, v10, 7, v9
    v_and_b32 v9, 3, v3
    v_lshlrev_b32 v9, 1, v9
    v_bfe_u32 v10, v3, 2, 1
    v_lshl_add_u32 v9, v10, 7, v9
    v_add_u32 v9, 0x100, v9
    v_and_b32 v10, 1, v3
    v_lshlrev_b32 v10, 2, v10
    v_bfe_u32 v8, v3, 1, 2
    v_lshl_add_u32 v10, v8, 7, v10
    v_add_u32 v10, 0x200, v10
    v_cmp_gt_u32 vcc, 8, v3
    s_nop 1
    v_cndmask_b32 v12, v10, v9, vcc
    v_lshlrev_b32 v8, 7, v3
    v_add_u32 v8, 0x400, v8
    s_movk_i32 s10, 2112
    v_mul_lo_u32 v9, v4, s10
    v_add_u32 v9, s7, v9
    v_lshrrev_b32 v10, 2, v3
    v_add_u32 v10, 25, v10
    v_lshl_add_u32 v144, v10, 3, v9
    v_and_b32 v10, 3, v3
    v_add_u32 v10, 29, v10
    v_lshl_add_u32 v145, v10, 3, v9
    v_lshrrev_b32 v10, 7, v6
    v_add_u32 v10, 8, v10
    v_lshl_add_u32 v146, v10, 3, v9
    v_and_b32 v10, 7, v6
    v_lshl_add_u32 v147, v10, 3, v9
    v_lshrrev_b32 v10, 7, v12
    v_add_u32 v10, 8, v10
    v_lshl_add_u32 v148, v10, 3, v9
    v_and_b32 v10, 7, v12
    v_lshl_add_u32 v149, v10, 3, v9
    v_lshrrev_b32 v10, 7, v8
    v_min_u32 v10, 16, v10
    v_add_u32 v10, 8, v10
    v_lshl_add_u32 v150, v10, 3, v9
    v_mov_b32 v160, 0
    v_mov_b32 v161, 0
    v_mov_b32 v162, 0
    v_mov_b32 v163, 0
    v_mov_b32 v164, 0
    v_mov_b32 v165, 0
    v_mov_b32 v166, 0
    v_mov_b32 v167, 0
    v_mov_b32 v168, 0
    v_mov_b32 v169, 0
    v_mov_b32 v170, 0
    v_mov_b32 v171, 0
    v_mov_b32 v159, s24
    v_lshlrev_b32 v10, 2, v4
    v_add_u32 v10, s9, v10
    v_and_b32 v11, 7, v10
    v_lshrrev_b32 v13, 3, v10
    v_lshl_add_u32 v44, v13, 7, v11
    v_and_b32 v11, 3, v10
    v_lshlrev_b32 v11, 1, v11
    v_bfe_u32 v13, v10, 2, 1
    v_lshl_add_u32 v11, v13, 7, v11
    v_add_u32 v11, 0x100, v11
    v_and_b32 v13, 1, v10
    v_lshlrev_b32 v13, 2, v13
    v_bfe_u32 v46, v10, 1, 2
    v_lshl_add_u32 v13, v46, 7, v13
    v_add_u32 v13, 0x200, v13
    v_cmp_gt_u32 vcc, 8, v10
    s_nop 1
    v_cndmask_b32 v45, v13, v11, vcc
    v_lshlrev_b32 v46, 7, v10
    v_add_u32 v46, 0x400, v46
    s_lshl_b32 s11, s8, 12
    s_add_u32 s11, s11, 139776
    s_movk_i32 s12, 0x7f
    s_movk_i32 s13, 0x800
    v_lshl_add_u32 v44, v3, 3, v44
    v_cvt_f32_u32 v48, v44
    v_lshrrev_b32 v48, 16, v48
    v_subrev_u32 v48, 0x4280, v48
    v_med3_i32 v48, v48, v44, s12
    v_mov_b32 v52, 1000
    v_cmp_ge_u32 vcc, s13, v44
    s_nop 1
    v_cndmask_b32 v48, v52, v48, vcc
    v_lshlrev_b32 v48, 2, v48
    v_add_u32 v152, s11, v48
    v_lshl_add_u32 v45, v3, 3, v45
    v_cvt_f32_u32 v49, v45
    v_lshrrev_b32 v49, 16, v49
    v_subrev_u32 v49, 0x4280, v49
    v_med3_i32 v49, v49, v45, s12
    v_mov_b32 v52, 1000
    v_cmp_ge_u32 vcc, s13, v45
    s_nop 1
    v_cndmask_b32 v49, v52, v49, vcc
    v_lshlrev_b32 v49, 2, v49
    v_add_u32 v153, s11, v49
    v_lshl_add_u32 v46, v3, 3, v46
    v_cvt_f32_u32 v50, v46
    v_lshrrev_b32 v50, 16, v50
    v_subrev_u32 v50, 0x4280, v50
    v_med3_i32 v50, v50, v46, s12
    v_mov_b32 v52, 1000
    v_cmp_ge_u32 vcc, s13, v46
    s_nop 1
    v_cndmask_b32 v50, v52, v50, vcc
    v_lshlrev_b32 v50, 2, v50
    v_add_u32 v154, s11, v50
    s_waitcnt vmcnt(13)
    v_lshlrev_b32 v14, 16, v14
    v_mul_f32 v15, s20, v14
    v_fma_f32 v16, v14, s20, -v15
    v_fma_f32 v16, v14, s21, v16
    v_exp_f32 v17, v15
    v_mul_f32 v16, s22, v16
    v_fma_f32 v17, v17, v16, v17
    v_cvt_pk_bf16_f32 v17, v17, v17
    v_lshlrev_b32 v201, 16, v17
    ds_write_b128 v206, v[208:211]
    s_waitcnt vmcnt(7)
    v_lshlrev_b32 v176, 16, v176
    v_lshlrev_b32 v177, 16, v177
    v_lshlrev_b32 v178, 16, v178
    v_lshlrev_b32 v179, 16, v179
    v_lshlrev_b32 v180, 16, v180
    v_lshlrev_b32 v181, 16, v181
    v_mul_f32 v8, v201, v176
    v_mul_f32 v9, v201, v177
    v_mul_f32 v8, s20, v8
    v_mul_f32 v9, s23, v9
    v_mul_f32 v10, v201, v178
    v_mul_f32 v11, v201, v179
    v_mul_f32 v28, v180, v10
    v_fma_f32 v28, -v181, v11, v28
    v_mul_f32 v29, v180, v11
    v_fma_f32 v29, v181, v10, v29
    v_mul_f32 v10, v8, v202
    v_mul_f32 v11, v9, v202
    v_mul_f32 v12, v8, v203
    v_mul_f32 v13, v9, v203
    v_exp_f32 v10, v10
    v_fract_f32 v11, v11
    v_exp_f32 v12, v12
    v_fract_f32 v13, v13
    v_cos_f32 v32, v11
    v_sin_f32 v33, v11
    v_cos_f32 v30, v13
    v_sin_f32 v31, v13
    v_mul_f32 v32, v10, v32
    v_mul_f32 v33, v10, v33
    v_mul_f32 v30, v12, v30
    v_mul_f32 v31, v12, v31
    v_mov_b32 v12, 1.0
    v_mov_b32 v13, 0
    v_mul_f32 v34, v32, v32
    v_mul_f32 v35, v32, v33
    v_fma_f32 v34, -v33, v33, v34
    v_fma_f32 v35, v33, v32, v35
    v_mul_f32 v46, v30, v30
    v_mul_f32 v47, v30, v31
    v_fma_f32 v46, -v31, v31, v46
    v_fma_f32 v47, v31, v30, v47
    v_mul_f32 v36, v34, v32
    v_mul_f32 v37, v34, v33
    v_fma_f32 v36, -v35, v33, v36
    v_fma_f32 v37, v35, v32, v37
    v_mul_f32 v38, v34, v34
    v_mul_f32 v39, v34, v35
    v_fma_f32 v38, -v35, v35, v38
    v_fma_f32 v39, v35, v34, v39
    v_mul_f32 v42, v36, v36
    v_mul_f32 v43, v36, v37
    v_fma_f32 v42, -v37, v37, v42
    v_fma_f32 v43, v37, v36, v43
    v_mul_f32 v40, v38, v32
    v_mul_f32 v41, v38, v33
    v_fma_f32 v40, -v39, v33, v40
    v_fma_f32 v41, v39, v32, v41
    v_mul_f32 v44, v38, v36
    v_mul_f32 v45, v38, v37
    v_fma_f32 v44, -v39, v37, v44
    v_fma_f32 v45, v39, v36, v45
    ds_write_b64 v205, v[12:13]
    ds_write_b64 v205, v[32:33] offset:8
    ds_write_b64 v205, v[34:35] offset:16
    ds_write_b64 v205, v[36:37] offset:24
    ds_write_b64 v205, v[38:39] offset:32
    ds_write_b64 v205, v[40:41] offset:40
    ds_write_b64 v205, v[42:43] offset:48
    ds_write_b64 v205, v[44:45] offset:56
    s_mov_b64 exec, s[26:27]
    ds_write_b64 v204, v[30:31] offset:128
    ds_write_b64 v204, v[46:47] offset:192
    v_mul_f32 v50, v30, v32
    v_mul_f32 v51, v30, v33
    v_fma_f32 v50, -v31, v33, v50
    v_fma_f32 v51, v31, v32, v51
    v_mul_f32 v52, v30, v34
    v_mul_f32 v53, v30, v35
    v_fma_f32 v52, -v31, v35, v52
    v_fma_f32 v53, v31, v34, v53
    v_mul_f32 v54, v30, v36
    v_mul_f32 v55, v30, v37
    v_fma_f32 v54, -v31, v37, v54
    v_fma_f32 v55, v31, v36, v55
    v_mul_f32 v56, v30, v38
    v_mul_f32 v57, v30, v39
    v_fma_f32 v56, -v31, v39, v56
    v_fma_f32 v57, v31, v38, v57
    v_mul_f32 v58, v30, v40
    v_mul_f32 v59, v30, v41
    v_fma_f32 v58, -v31, v41, v58
    v_fma_f32 v59, v31, v40, v59
    v_mul_f32 v60, v30, v42
    v_mul_f32 v61, v30, v43
    v_fma_f32 v60, -v31, v43, v60
    v_fma_f32 v61, v31, v42, v61
    v_mul_f32 v62, v30, v44
    v_mul_f32 v63, v30, v45
    v_fma_f32 v62, -v31, v45, v62
    v_fma_f32 v63, v31, v44, v63
    ds_write_b64 v204, v[50:51] offset:136
    ds_write_b64 v204, v[52:53] offset:144
    ds_write_b64 v204, v[54:55] offset:152
    ds_write_b64 v204, v[56:57] offset:160
    ds_write_b64 v204, v[58:59] offset:168
    ds_write_b64 v204, v[60:61] offset:176
    ds_write_b64 v204, v[62:63] offset:184
    s_not_b64 exec, s[26:27]
    v_mul_f32 v50, v46, v30
    v_mul_f32 v51, v46, v31
    v_fma_f32 v50, -v47, v31, v50
    v_fma_f32 v51, v47, v30, v51
    v_mul_f32 v52, v46, v46
    v_mul_f32 v53, v46, v47
    v_fma_f32 v52, -v47, v47, v52
    v_fma_f32 v53, v47, v46, v53
    v_mul_f32 v58, v28, v30
    v_mul_f32 v59, v28, v31
    v_fma_f32 v58, -v29, v31, v58
    v_fma_f32 v59, v29, v30, v59
    v_mul_f32 v60, v28, v46
    v_mul_f32 v61, v28, v47
    v_fma_f32 v60, -v29, v47, v60
    v_fma_f32 v61, v29, v46, v61
    v_mul_f32 v54, v52, v52
    v_mul_f32 v55, v52, v53
    v_fma_f32 v54, -v53, v53, v54
    v_fma_f32 v55, v53, v52, v55
    v_mul_f32 v62, v28, v50
    v_mul_f32 v63, v28, v51
    v_fma_f32 v62, -v29, v51, v62
    v_fma_f32 v63, v29, v50, v63
    v_mul_f32 v56, v54, v52
    v_mul_f32 v57, v54, v53
    v_fma_f32 v56, -v55, v53, v56
    v_fma_f32 v57, v55, v52, v57
    ds_write_b64 v204, v[12:13] offset:200
    ds_write_b64 v204, v[52:53] offset:208
    ds_write_b64 v204, v[54:55] offset:216
    ds_write_b64 v204, v[56:57] offset:224
    ds_write_b64 v204, v[28:29] offset:232
    ds_write_b64 v204, v[58:59] offset:240
    ds_write_b64 v204, v[60:61] offset:248
    ds_write_b64 v204, v[62:63] offset:256
    s_mov_b64 exec, -1
    s_waitcnt lgkmcnt(0)
    s_barrier
    v_bfe_u32 v8, v2, 2, 2
    v_lshl_add_u32 v8, v4, 3, v8
    s_lshr_b32 s7, s6, 2
    s_lshl_b32 s10, s7, 5
    v_add_u32 v8, s10, v8
    s_movk_i32 s10, 144
    v_mul_lo_u32 v8, v8, s10
    v_and_b32 v9, 3, v2
    v_lshl_add_u32 v8, v9, 3, v8
    s_lshl_b32 s10, s9, 5
    s_add_u32 s10, s10, 148096
    v_add_u32 v8, s10, v8
    ds_read_b64_tr_b16 v[208:209], v8
    ds_read_b64_tr_b16 v[210:211], v8 offset:576
    s_lshl_b32 s10, s67, 6
    s_lshl_b32 s13, s9, 4
    s_add_u32 s10, s10, s13
    v_add_u32 v9, s10, v3
    v_lshlrev_b32 v9, 12, v9
    v_lshl_add_u32 v9, v4, 4, v9
    s_lshl_b32 s10, s66, 7
    s_lshl_b32 s13, s7, 6
    s_add_u32 s10, s10, s13
    s_add_u32 s10, s10, 0x200000
    v_add_u32 v9, s10, v9
    s_waitcnt lgkmcnt(0)
    global_store_dwordx4 v9, v[208:211], s[64:65] sc1
    v_mov_b32 v207, 0
    global_load_dword v207, v207, s[62:63] sc1
    ds_read_b64 v[16:17], v144 offset:0
    ds_read_b64 v[18:19], v145 offset:0
    ds_read_b64 v[20:21], v146 offset:0
    ds_read_b64 v[22:23], v147 offset:0
    ds_read_b64 v[24:25], v148 offset:0
    ds_read_b64 v[26:27], v149 offset:0
    ds_read_b64 v[28:29], v150 offset:0
    ds_read_b64 v[30:31], v144 offset:264
    ds_read_b64 v[32:33], v145 offset:264
    ds_read_b64 v[34:35], v146 offset:264
    ds_read_b64 v[36:37], v147 offset:264
    ds_read_b64 v[38:39], v148 offset:264
    ds_read_b64 v[40:41], v149 offset:264
    ds_read_b64 v[42:43], v150 offset:264
    ds_read_b64 v[44:45], v144 offset:528
    ds_read_b64 v[46:47], v145 offset:528
    ds_read_b64 v[48:49], v146 offset:528
    ds_read_b64 v[50:51], v147 offset:528
    ds_read_b64 v[52:53], v148 offset:528
    ds_read_b64 v[54:55], v149 offset:528
    ds_read_b64 v[56:57], v150 offset:528
    s_waitcnt lgkmcnt(14)
    v_mul_f32 v58, v16, v18
    v_mul_f32 v59, v16, v19
    v_mul_f32 v60, v20, v22
    v_mul_f32 v61, v20, v23
    v_mul_f32 v62, v24, v26
    v_mul_f32 v63, v24, v27
    v_fma_f32 v58, -v17, v19, v58
    v_fma_f32 v59, -v17, v18, -v59
    v_fma_f32 v60, -v21, v23, v60
    v_fma_f32 v61, v21, v22, v61
    v_fma_f32 v62, -v25, v27, v62
    v_fma_f32 v63, v25, v26, v63
    v_perm_b32 v104, v29, v28, s25
    v_and_b32 v72, v159, v28
    v_and_b32 v73, v159, v29
    v_perm_b32 v80, v59, v58, s25
    v_and_b32 v66, v159, v58
    v_and_b32 v67, v159, v59
    v_perm_b32 v88, v61, v60, s25
    v_and_b32 v68, v159, v60
    v_and_b32 v69, v159, v61
    v_perm_b32 v96, v63, v62, s25
    v_and_b32 v70, v159, v62
    v_and_b32 v71, v159, v63
    v_sub_f32 v72, v28, v72
    v_sub_f32 v73, v29, v73
    v_sub_f32 v66, v58, v66
    v_sub_f32 v67, v59, v67
    v_sub_f32 v68, v60, v68
    v_sub_f32 v69, v61, v69
    v_sub_f32 v70, v62, v70
    v_sub_f32 v71, v63, v71
    v_perm_b32 v108, v73, v72, s25
    v_perm_b32 v84, v67, v66, s25
    v_perm_b32 v92, v69, v68, s25
    v_perm_b32 v100, v71, v70, s25
    ds_read_b64 v[16:17], v144 offset:792
    ds_read_b64 v[18:19], v145 offset:792
    ds_read_b64 v[20:21], v146 offset:792
    ds_read_b64 v[22:23], v147 offset:792
    ds_read_b64 v[24:25], v148 offset:792
    ds_read_b64 v[26:27], v149 offset:792
    ds_read_b64 v[28:29], v150 offset:792
    s_waitcnt lgkmcnt(14)
    v_mul_f32 v58, v30, v32
    v_mul_f32 v59, v30, v33
    v_mul_f32 v60, v34, v36
    v_mul_f32 v61, v34, v37
    v_mul_f32 v62, v38, v40
    v_mul_f32 v63, v38, v41
    v_fma_f32 v58, -v31, v33, v58
    v_fma_f32 v59, -v31, v32, -v59
    v_fma_f32 v60, -v35, v37, v60
    v_fma_f32 v61, v35, v36, v61
    v_fma_f32 v62, -v39, v41, v62
    v_fma_f32 v63, v39, v40, v63
    v_perm_b32 v105, v43, v42, s25
    v_and_b32 v72, v159, v42
    v_and_b32 v73, v159, v43
    v_perm_b32 v81, v59, v58, s25
    v_and_b32 v66, v159, v58
    v_and_b32 v67, v159, v59
    v_perm_b32 v89, v61, v60, s25
    v_and_b32 v68, v159, v60
    v_and_b32 v69, v159, v61
    v_perm_b32 v97, v63, v62, s25
    v_and_b32 v70, v159, v62
    v_and_b32 v71, v159, v63
    v_sub_f32 v72, v42, v72
    v_sub_f32 v73, v43, v73
    v_sub_f32 v66, v58, v66
    v_sub_f32 v67, v59, v67
    v_sub_f32 v68, v60, v68
    v_sub_f32 v69, v61, v69
    v_sub_f32 v70, v62, v70
    v_sub_f32 v71, v63, v71
    v_perm_b32 v109, v73, v72, s25
    v_perm_b32 v85, v67, v66, s25
    v_perm_b32 v93, v69, v68, s25
    v_perm_b32 v101, v71, v70, s25
    ds_read_b64 v[30:31], v144 offset:1056
    ds_read_b64 v[32:33], v145 offset:1056
    ds_read_b64 v[34:35], v146 offset:1056
    ds_read_b64 v[36:37], v147 offset:1056
    ds_read_b64 v[38:39], v148 offset:1056
    ds_read_b64 v[40:41], v149 offset:1056
    ds_read_b64 v[42:43], v150 offset:1056
    s_waitcnt lgkmcnt(14)
    v_mul_f32 v58, v44, v46
    v_mul_f32 v59, v44, v47
    v_mul_f32 v60, v48, v50
    v_mul_f32 v61, v48, v51
    v_mul_f32 v62, v52, v54
    v_mul_f32 v63, v52, v55
    v_fma_f32 v58, -v45, v47, v58
    v_fma_f32 v59, -v45, v46, -v59
    v_fma_f32 v60, -v49, v51, v60
    v_fma_f32 v61, v49, v50, v61
    v_fma_f32 v62, -v53, v55, v62
    v_fma_f32 v63, v53, v54, v63
    v_perm_b32 v106, v57, v56, s25
    v_and_b32 v72, v159, v56
    v_and_b32 v73, v159, v57
    v_perm_b32 v82, v59, v58, s25
    v_and_b32 v66, v159, v58
    v_and_b32 v67, v159, v59
    v_perm_b32 v90, v61, v60, s25
    v_and_b32 v68, v159, v60
    v_and_b32 v69, v159, v61
    v_perm_b32 v98, v63, v62, s25
    v_and_b32 v70, v159, v62
    v_and_b32 v71, v159, v63
    v_sub_f32 v72, v56, v72
    v_sub_f32 v73, v57, v73
    v_sub_f32 v66, v58, v66
    v_sub_f32 v67, v59, v67
    v_sub_f32 v68, v60, v68
    v_sub_f32 v69, v61, v69
    v_sub_f32 v70, v62, v70
    v_sub_f32 v71, v63, v71
    v_perm_b32 v110, v73, v72, s25
    v_perm_b32 v86, v67, v66, s25
    v_perm_b32 v94, v69, v68, s25
    v_perm_b32 v102, v71, v70, s25
    ds_read_b64 v[44:45], v144 offset:1320
    ds_read_b64 v[46:47], v145 offset:1320
    ds_read_b64 v[48:49], v146 offset:1320
    ds_read_b64 v[50:51], v147 offset:1320
    ds_read_b64 v[52:53], v148 offset:1320
    ds_read_b64 v[54:55], v149 offset:1320
    ds_read_b64 v[56:57], v150 offset:1320
    s_waitcnt lgkmcnt(14)
    v_mul_f32 v58, v16, v18
    v_mul_f32 v59, v16, v19
    v_mul_f32 v60, v20, v22
    v_mul_f32 v61, v20, v23
    v_mul_f32 v62, v24, v26
    v_mul_f32 v63, v24, v27
    v_fma_f32 v58, -v17, v19, v58
    v_fma_f32 v59, -v17, v18, -v59
    v_fma_f32 v60, -v21, v23, v60
    v_fma_f32 v61, v21, v22, v61
    v_fma_f32 v62, -v25, v27, v62
    v_fma_f32 v63, v25, v26, v63
    v_perm_b32 v107, v29, v28, s25
    v_and_b32 v72, v159, v28
    v_and_b32 v73, v159, v29
    v_perm_b32 v83, v59, v58, s25
    v_and_b32 v66, v159, v58
    v_and_b32 v67, v159, v59
    v_perm_b32 v91, v61, v60, s25
    v_and_b32 v68, v159, v60
    v_and_b32 v69, v159, v61
    v_perm_b32 v99, v63, v62, s25
    v_and_b32 v70, v159, v62
    v_and_b32 v71, v159, v63
    v_sub_f32 v72, v28, v72
    v_sub_f32 v73, v29, v73
    v_sub_f32 v66, v58, v66
    v_sub_f32 v67, v59, v67
    v_sub_f32 v68, v60, v68
    v_sub_f32 v69, v61, v69
    v_sub_f32 v70, v62, v70
    v_sub_f32 v71, v63, v71
    v_perm_b32 v111, v73, v72, s25
    v_perm_b32 v87, v67, v66, s25
    v_perm_b32 v95, v69, v68, s25
    v_perm_b32 v103, v71, v70, s25
    s_waitcnt vmcnt(0)
    v_readfirstlane_b32 s68, v207
    s_nop 0
    s_cmp_lg_u32 s68, 0
    s_cbranch_scc1 K12_T1_OK
    s_mov_b32 s69, 0
K12_T1_L:
    s_sleep 4
    v_mov_b32 v207, 0
    global_load_dword v207, v207, s[62:63] sc1
    s_waitcnt vmcnt(0)
    v_readfirstlane_b32 s68, v207
    s_add_u32 s69, s69, 1
    s_cmp_lg_u32 s68, 0
    s_cbranch_scc1 K12_T1_OK
    s_cmp_lt_u32 s69, 20000
    s_cbranch_scc1 K12_T1_L
K12_T1_OK:
    v_mov_b32 v7, 1
    v_mov_b32 v15, 147968
    s_mov_b64 exec, 1
    ds_add_rtn_u32 v7, v15, v7
    s_waitcnt lgkmcnt(0)
    v_readfirstlane_b32 s7, v7
    s_nop 0
    s_cmp_lg_u32 s7, 7
    s_cbranch_scc1 K12_NOSIG1
    v_mov_b32 v7, s68
    s_lshl_b32 s7, s3, 7
    s_add_u32 s7, s7, 0x10000
    v_mov_b32 v15, s7
    global_store_dword v15, v7, s[64:65] sc1
K12_NOSIG1:
    s_mov_b64 exec, -1
    s_lshl_b32 s5, s4, 12
    s_mul_i32 s10, s8, 26624
    v_and_b32 v155, 0xff, v0
    v_lshlrev_b32 v156, 4, v155
    v_lshlrev_b32 v157, 2, v156
    s_add_u32 s16, s64, s5
    s_addc_u32 s17, s65, 0
    s_add_u32 s30, s16, 0x800000
    s_addc_u32 s31, s17, 0
    s_add_u32 s16, s16, 0x200000
    s_addc_u32 s17, s17, 0
    v_mov_b32 v158, 147972
    s_mov_b32 s15, 0
    s_lshr_b32 s14, s4, 6
    s_lshl_b32 s14, s14, 5
    v_and_b32 v151, 31, v2
    v_add_u32 v8, s14, v151
    v_add_u32 v151, 224, v151
    v_cmp_gt_u32 vcc, 32, v2
    s_nop 1
    v_cndmask_b32 v151, v151, v8, vcc
    v_lshlrev_b32 v151, 7, v151
    v_add_u32 v151, 0x10000, v151
    v_mov_b32 v206, 0
    ds_read_b64 v[16:17], v144 offset:1584
    ds_read_b64 v[18:19], v145 offset:1584
    ds_read_b64 v[20:21], v146 offset:1584
    ds_read_b64 v[22:23], v147 offset:1584
    ds_read_b64 v[24:25], v148 offset:1584
    ds_read_b64 v[26:27], v149 offset:1584
    ds_read_b64 v[28:29], v150 offset:1584
    s_waitcnt lgkmcnt(14)
    v_mul_f32 v58, v30, v32
    v_mul_f32 v59, v30, v33
    v_mul_f32 v60, v34, v36
    v_mul_f32 v61, v34, v37
    v_mul_f32 v62, v38, v40
    v_mul_f32 v63, v38, v41
    v_fma_f32 v58, -v31, v33, v58
    v_fma_f32 v59, -v31, v32, -v59
    v_fma_f32 v60, -v35, v37, v60
    v_fma_f32 v61, v35, v36, v61
    v_fma_f32 v62, -v39, v41, v62
    v_fma_f32 v63, v39, v40, v63
    v_perm_b32 v136, v43, v42, s25
    v_and_b32 v72, v159, v42
    v_and_b32 v73, v159, v43
    v_perm_b32 v112, v59, v58, s25
    v_and_b32 v66, v159, v58
    v_mfma_f32_16x16x32_bf16 v[160:163], v[88:91], v[80:83], v[160:163]
    v_and_b32 v67, v159, v59
    v_perm_b32 v120, v61, v60, s25
    v_and_b32 v68, v159, v60
    v_and_b32 v69, v159, v61
    v_perm_b32 v128, v63, v62, s25
    v_and_b32 v70, v159, v62
    v_and_b32 v71, v159, v63
    v_sub_f32 v72, v42, v72
    v_sub_f32 v73, v43, v73
    v_sub_f32 v66, v58, v66
    v_sub_f32 v67, v59, v67
    v_sub_f32 v68, v60, v68
    v_sub_f32 v69, v61, v69
    v_sub_f32 v70, v62, v70
    v_sub_f32 v71, v63, v71
    v_perm_b32 v140, v73, v72, s25
    v_perm_b32 v116, v67, v66, s25
    v_mfma_f32_16x16x32_bf16 v[160:163], v[88:91], v[84:87], v[160:163]
    v_perm_b32 v124, v69, v68, s25
    v_perm_b32 v132, v71, v70, s25
    ds_read_b64 v[30:31], v144 offset:1848
    ds_read_b64 v[32:33], v145 offset:1848
    ds_read_b64 v[34:35], v146 offset:1848
    ds_read_b64 v[36:37], v147 offset:1848
    ds_read_b64 v[38:39], v148 offset:1848
    ds_read_b64 v[40:41], v149 offset:1848
    ds_read_b64 v[42:43], v150 offset:1848
    s_waitcnt lgkmcnt(14)
    v_mul_f32 v58, v44, v46
    v_mul_f32 v59, v44, v47
    v_mul_f32 v60, v48, v50
    v_mul_f32 v61, v48, v51
    v_mul_f32 v62, v52, v54
    v_mul_f32 v63, v52, v55
    v_fma_f32 v58, -v45, v47, v58
    v_mfma_f32_16x16x32_bf16 v[160:163], v[92:95], v[80:83], v[160:163]
    v_fma_f32 v59, -v45, v46, -v59
    v_fma_f32 v60, -v49, v51, v60
    v_fma_f32 v61, v49, v50, v61
    v_fma_f32 v62, -v53, v55, v62
    v_fma_f32 v63, v53, v54, v63
    v_perm_b32 v137, v57, v56, s25
    v_and_b32 v72, v159, v56
    v_and_b32 v73, v159, v57
    v_perm_b32 v113, v59, v58, s25
    v_and_b32 v66, v159, v58
    v_and_b32 v67, v159, v59
    v_perm_b32 v121, v61, v60, s25
    v_and_b32 v68, v159, v60
    v_and_b32 v69, v159, v61
    v_perm_b32 v129, v63, v62, s25
    v_and_b32 v70, v159, v62
    v_and_b32 v71, v159, v63
    v_mfma_f32_16x16x32_bf16 v[164:167], v[96:99], v[80:83], v[164:167]
    v_sub_f32 v72, v56, v72
    v_sub_f32 v73, v57, v73
    v_sub_f32 v66, v58, v66
    v_sub_f32 v67, v59, v67
    v_sub_f32 v68, v60, v68
    v_sub_f32 v69, v61, v69
    v_sub_f32 v70, v62, v70
    v_sub_f32 v71, v63, v71
    v_perm_b32 v141, v73, v72, s25
    v_perm_b32 v117, v67, v66, s25
    v_perm_b32 v125, v69, v68, s25
    v_perm_b32 v133, v71, v70, s25
    s_waitcnt lgkmcnt(7)
    v_mul_f32 v58, v16, v18
    v_mul_f32 v59, v16, v19
    v_mul_f32 v60, v20, v22
    v_mul_f32 v61, v20, v23
    v_mfma_f32_16x16x32_bf16 v[164:167], v[96:99], v[84:87], v[164:167]
    v_mul_f32 v62, v24, v26
    v_mul_f32 v63, v24, v27
    v_fma_f32 v58, -v17, v19, v58
    v_fma_f32 v59, -v17, v18, -v59
    v_fma_f32 v60, -v21, v23, v60
    v_fma_f32 v61, v21, v22, v61
    v_fma_f32 v62, -v25, v27, v62
    v_fma_f32 v63, v25, v26, v63
    v_perm_b32 v138, v29, v28, s25
    v_and_b32 v72, v159, v28
    v_and_b32 v73, v159, v29
    v_perm_b32 v114, v59, v58, s25
    v_and_b32 v66, v159, v58
    v_and_b32 v67, v159, v59
    v_perm_b32 v122, v61, v60, s25
    v_and_b32 v68, v159, v60
    v_and_b32 v69, v159, v61
    v_mfma_f32_16x16x32_bf16 v[164:167], v[100:103], v[80:83], v[164:167]
    v_perm_b32 v130, v63, v62, s25
    v_and_b32 v70, v159, v62
    v_and_b32 v71, v159, v63
    v_sub_f32 v72, v28, v72
    v_sub_f32 v73, v29, v73
    v_sub_f32 v66, v58, v66
    v_sub_f32 v67, v59, v67
    v_sub_f32 v68, v60, v68
    v_sub_f32 v69, v61, v69
    v_sub_f32 v70, v62, v70
    v_sub_f32 v71, v63, v71
    v_perm_b32 v142, v73, v72, s25
    v_perm_b32 v118, v67, v66, s25
    v_perm_b32 v126, v69, v68, s25
    v_perm_b32 v134, v71, v70, s25
    s_waitcnt lgkmcnt(0)
    v_mul_f32 v58, v30, v32
    v_mfma_f32_16x16x32_bf16 v[168:171], v[104:107], v[80:83], v[168:171]
    v_mul_f32 v59, v30, v33
    v_mul_f32 v60, v34, v36
    v_mul_f32 v61, v34, v37
    v_mul_f32 v62, v38, v40
    v_mul_f32 v63, v38, v41
    v_fma_f32 v58, -v31, v33, v58
    v_fma_f32 v59, -v31, v32, -v59
    v_fma_f32 v60, -v35, v37, v60
    v_fma_f32 v61, v35, v36, v61
    v_fma_f32 v62, -v39, v41, v62
    v_fma_f32 v63, v39, v40, v63
    v_perm_b32 v139, v43, v42, s25
    v_and_b32 v72, v159, v42
    v_and_b32 v73, v159, v43
    v_perm_b32 v115, v59, v58, s25
    v_and_b32 v66, v159, v58
    v_and_b32 v67, v159, v59
    v_mfma_f32_16x16x32_bf16 v[168:171], v[104:107], v[84:87], v[168:171]
    v_perm_b32 v123, v61, v60, s25
    v_and_b32 v68, v159, v60
    v_and_b32 v69, v159, v61
    v_perm_b32 v131, v63, v62, s25
    v_and_b32 v70, v159, v62
    v_and_b32 v71, v159, v63
    v_sub_f32 v72, v42, v72
    v_sub_f32 v73, v43, v73
    v_sub_f32 v66, v58, v66
    v_sub_f32 v67, v59, v67
    v_sub_f32 v68, v60, v68
    v_sub_f32 v69, v61, v69
    v_sub_f32 v70, v62, v70
    v_sub_f32 v71, v63, v71
    v_perm_b32 v143, v73, v72, s25
    v_perm_b32 v119, v67, v66, s25
    v_perm_b32 v127, v69, v68, s25
    v_mfma_f32_16x16x32_bf16 v[168:171], v[108:111], v[80:83], v[168:171]
    v_perm_b32 v135, v71, v70, s25
    s_cmp_lg_u32 s15, 0
    s_cbranch_scc1 K12_CP0_END
    s_cmp_lg_u32 s6, 0
    s_cbranch_scc1 K12_CP0_LDS
    s_waitcnt vmcnt(0)
    v_cmp_ne_u32 vcc, s68, v206
    s_cbranch_vccz K12_CP0_GO
    global_load_dword v206, v151, s[64:65] sc1
    s_branch K12_CP0_END
K12_CP0_GO:
    v_mov_b32 v7, 1
    ds_write_b32 v158, v7
    s_branch K12_CP0_LD
K12_CP0_LDS:
    ds_read_b32 v7, v158
    s_waitcnt lgkmcnt(0)
    v_readfirstlane_b32 s13, v7
    s_nop 0
    s_cmp_eq_u32 s13, 0
    s_cbranch_scc1 K12_CP0_END
K12_CP0_LD:
    global_load_dwordx4 v[196:199], v156, s[16:17] sc1
    global_load_dwordx4 v[208:211], v157, s[64:65] offset:0 sc1
    global_load_dwordx4 v[212:215], v157, s[64:65] offset:16 sc1
    global_load_dwordx4 v[216:219], v157, s[64:65] offset:32 sc1
    global_load_dwordx4 v[220:223], v157, s[64:65] offset:48 sc1
    s_mov_b32 s15, 1
K12_CP0_END:
    s_waitcnt lgkmcnt(0)
    v_lshlrev_b32 v184, 16, v184
    v_lshlrev_b32 v185, 16, v185
    v_lshlrev_b32 v186, 16, v186
    v_lshlrev_b32 v187, 16, v187
    v_lshlrev_b32 v188, 16, v188
    v_lshlrev_b32 v189, 16, v189
    v_mul_f32 v8, v201, v184
    v_mul_f32 v9, v201, v185
    v_mul_f32 v8, s20, v8
    v_mul_f32 v9, s23, v9
    v_mul_f32 v10, v201, v186
    v_mul_f32 v11, v201, v187
    v_mul_f32 v28, v188, v10
    v_fma_f32 v28, -v189, v11, v28
    v_mul_f32 v29, v188, v11
    v_fma_f32 v29, v189, v10, v29
    v_mul_f32 v10, v8, v202
    v_mul_f32 v11, v9, v202
    v_mul_f32 v12, v8, v203
    v_mul_f32 v13, v9, v203
    v_exp_f32 v10, v10
    v_fract_f32 v11, v11
    v_exp_f32 v12, v12
    v_fract_f32 v13, v13
    v_cos_f32 v32, v11
    v_sin_f32 v33, v11
    v_cos_f32 v30, v13
    v_sin_f32 v31, v13
    v_mul_f32 v32, v10, v32
    v_mul_f32 v33, v10, v33
    v_mul_f32 v30, v12, v30
    v_mul_f32 v31, v12, v31
    v_mov_b32 v12, 1.0
    v_mov_b32 v13, 0
    v_mul_f32 v34, v32, v32
    v_mul_f32 v35, v32, v33
    v_fma_f32 v34, -v33, v33, v34
    v_fma_f32 v35, v33, v32, v35
    v_mul_f32 v46, v30, v30
    v_mul_f32 v47, v30, v31
    v_fma_f32 v46, -v31, v31, v46
    v_fma_f32 v47, v31, v30, v47
    v_mul_f32 v36, v34, v32
    v_mul_f32 v37, v34, v33
    v_fma_f32 v36, -v35, v33, v36
    v_fma_f32 v37, v35, v32, v37
    v_mul_f32 v38, v34, v34
    v_mul_f32 v39, v34, v35
    v_fma_f32 v38, -v35, v35, v38
    v_fma_f32 v39, v35, v34, v39
    v_mul_f32 v42, v36, v36
    v_mul_f32 v43, v36, v37
    v_fma_f32 v42, -v37, v37, v42
    v_fma_f32 v43, v37, v36, v43
    v_mul_f32 v40, v38, v32
    v_mul_f32 v41, v38, v33
    v_fma_f32 v40, -v39, v33, v40
    v_fma_f32 v41, v39, v32, v41
    v_mul_f32 v44, v38, v36
    v_mul_f32 v45, v38, v37
    v_fma_f32 v44, -v39, v37, v44
    v_fma_f32 v45, v39, v36, v45
    ds_write_b64 v205, v[12:13]
    ds_write_b64 v205, v[32:33] offset:8
    ds_write_b64 v205, v[34:35] offset:16
    ds_write_b64 v205, v[36:37] offset:24
    ds_write_b64 v205, v[38:39] offset:32
    ds_write_b64 v205, v[40:41] offset:40
    ds_write_b64 v205, v[42:43] offset:48
    ds_write_b64 v205, v[44:45] offset:56
    s_mov_b64 exec, s[26:27]
    ds_write_b64 v204, v[30:31] offset:128
    ds_write_b64 v204, v[46:47] offset:192
    v_mul_f32 v50, v30, v32
    v_mul_f32 v51, v30, v33
    v_fma_f32 v50, -v31, v33, v50
    v_fma_f32 v51, v31, v32, v51
    v_mul_f32 v52, v30, v34
    v_mul_f32 v53, v30, v35
    v_fma_f32 v52, -v31, v35, v52
    v_fma_f32 v53, v31, v34, v53
    v_mul_f32 v54, v30, v36
    v_mul_f32 v55, v30, v37
    v_fma_f32 v54, -v31, v37, v54
    v_fma_f32 v55, v31, v36, v55
    v_mul_f32 v56, v30, v38
    v_mul_f32 v57, v30, v39
    v_fma_f32 v56, -v31, v39, v56
    v_fma_f32 v57, v31, v38, v57
    v_mul_f32 v58, v30, v40
    v_mul_f32 v59, v30, v41
    v_fma_f32 v58, -v31, v41, v58
    v_fma_f32 v59, v31, v40, v59
    v_mul_f32 v60, v30, v42
    v_mul_f32 v61, v30, v43
    v_fma_f32 v60, -v31, v43, v60
    v_fma_f32 v61, v31, v42, v61
    v_mul_f32 v62, v30, v44
    v_mul_f32 v63, v30, v45
    v_fma_f32 v62, -v31, v45, v62
    v_fma_f32 v63, v31, v44, v63
    ds_write_b64 v204, v[50:51] offset:136
    ds_write_b64 v204, v[52:53] offset:144
    ds_write_b64 v204, v[54:55] offset:152
    ds_write_b64 v204, v[56:57] offset:160
    ds_write_b64 v204, v[58:59] offset:168
    ds_write_b64 v204, v[60:61] offset:176
    ds_write_b64 v204, v[62:63] offset:184
    s_not_b64 exec, s[26:27]
    v_mul_f32 v50, v46, v30
    v_mul_f32 v51, v46, v31
    v_fma_f32 v50, -v47, v31, v50
    v_fma_f32 v51, v47, v30, v51
    v_mul_f32 v52, v46, v46
    v_mul_f32 v53, v46, v47
    v_fma_f32 v52, -v47, v47, v52
    v_fma_f32 v53, v47, v46, v53
    v_mul_f32 v58, v28, v30
    v_mul_f32 v59, v28, v31
    v_fma_f32 v58, -v29, v31, v58
    v_fma_f32 v59, v29, v30, v59
    v_mul_f32 v60, v28, v46
    v_mul_f32 v61, v28, v47
    v_fma_f32 v60, -v29, v47, v60
    v_fma_f32 v61, v29, v46, v61
    v_mul_f32 v54, v52, v52
    v_mul_f32 v55, v52, v53
    v_fma_f32 v54, -v53, v53, v54
    v_fma_f32 v55, v53, v52, v55
    v_mul_f32 v62, v28, v50
    v_mul_f32 v63, v28, v51
    v_fma_f32 v62, -v29, v51, v62
    v_fma_f32 v63, v29, v50, v63
    v_mul_f32 v56, v54, v52
    v_mul_f32 v57, v54, v53
    v_fma_f32 v56, -v55, v53, v56
    v_fma_f32 v57, v55, v52, v57
    ds_write_b64 v204, v[12:13] offset:200
    ds_write_b64 v204, v[52:53] offset:208
    ds_write_b64 v204, v[54:55] offset:216
    ds_write_b64 v204, v[56:57] offset:224
    ds_write_b64 v204, v[28:29] offset:232
    ds_write_b64 v204, v[58:59] offset:240
    ds_write_b64 v204, v[60:61] offset:248
    ds_write_b64 v204, v[62:63] offset:256
    s_mov_b64 exec, -1
    v_mfma_f32_16x16x32_bf16 v[160:163], v[120:123], v[112:115], v[160:163]
    v_mfma_f32_16x16x32_bf16 v[160:163], v[120:123], v[116:119], v[160:163]
    v_mfma_f32_16x16x32_bf16 v[160:163], v[124:127], v[112:115], v[160:163]
    v_mfma_f32_16x16x32_bf16 v[164:167], v[128:131], v[112:115], v[164:167]
    v_mfma_f32_16x16x32_bf16 v[164:167], v[128:131], v[116:119], v[164:167]
    v_mfma_f32_16x16x32_bf16 v[164:167], v[132:135], v[112:115], v[164:167]
    v_mfma_f32_16x16x32_bf16 v[168:171], v[136:139], v[112:115], v[168:171]
    v_mfma_f32_16x16x32_bf16 v[168:171], v[136:139], v[116:119], v[168:171]
    v_mfma_f32_16x16x32_bf16 v[168:171], v[140:143], v[112:115], v[168:171]
    s_waitcnt lgkmcnt(0)
    ds_read_b64 v[16:17], v144 offset:0
    ds_read_b64 v[18:19], v145 offset:0
    ds_read_b64 v[20:21], v146 offset:0
    ds_read_b64 v[22:23], v147 offset:0
    ds_read_b64 v[24:25], v148 offset:0
    ds_read_b64 v[26:27], v149 offset:0
    ds_read_b64 v[28:29], v150 offset:0
    ds_read_b64 v[30:31], v144 offset:264
    ds_read_b64 v[32:33], v145 offset:264
    ds_read_b64 v[34:35], v146 offset:264
    ds_read_b64 v[36:37], v147 offset:264
    ds_read_b64 v[38:39], v148 offset:264
    ds_read_b64 v[40:41], v149 offset:264
    ds_read_b64 v[42:43], v150 offset:264
    ds_read_b64 v[44:45], v144 offset:528
    ds_read_b64 v[46:47], v145 offset:528
    ds_read_b64 v[48:49], v146 offset:528
    ds_read_b64 v[50:51], v147 offset:528
    ds_read_b64 v[52:53], v148 offset:528
    ds_read_b64 v[54:55], v149 offset:528
    ds_read_b64 v[56:57], v150 offset:528
    s_waitcnt lgkmcnt(14)
    v_mul_f32 v58, v16, v18
    v_mul_f32 v59, v16, v19
    v_mul_f32 v60, v20, v22
    v_mul_f32 v61, v20, v23
    v_mul_f32 v62, v24, v26
    v_mul_f32 v63, v24, v27
    v_fma_f32 v58, -v17, v19, v58
    v_fma_f32 v59, -v17, v18, -v59
    v_fma_f32 v60, -v21, v23, v60
    v_fma_f32 v61, v21, v22, v61
    v_fma_f32 v62, -v25, v27, v62
    v_fma_f32 v63, v25, v26, v63
    v_perm_b32 v104, v29, v28, s25
    v_and_b32 v72, v159, v28
    v_and_b32 v73, v159, v29
    v_perm_b32 v80, v59, v58, s25
    v_and_b32 v66, v159, v58
    v_and_b32 v67, v159, v59
    v_perm_b32 v88, v61, v60, s25
    v_and_b32 v68, v159, v60
    v_and_b32 v69, v159, v61
    v_perm_b32 v96, v63, v62, s25
    v_and_b32 v70, v159, v62
    v_and_b32 v71, v159, v63
    v_sub_f32 v72, v28, v72
    v_sub_f32 v73, v29, v73
    v_sub_f32 v66, v58, v66
    v_sub_f32 v67, v59, v67
    v_sub_f32 v68, v60, v68
    v_sub_f32 v69, v61, v69
    v_sub_f32 v70, v62, v70
    v_sub_f32 v71, v63, v71
    v_perm_b32 v108, v73, v72, s25
    v_perm_b32 v84, v67, v66, s25
    v_perm_b32 v92, v69, v68, s25
    v_perm_b32 v100, v71, v70, s25
    ds_read_b64 v[16:17], v144 offset:792
    ds_read_b64 v[18:19], v145 offset:792
    ds_read_b64 v[20:21], v146 offset:792
    ds_read_b64 v[22:23], v147 offset:792
    ds_read_b64 v[24:25], v148 offset:792
    ds_read_b64 v[26:27], v149 offset:792
    ds_read_b64 v[28:29], v150 offset:792
    s_waitcnt lgkmcnt(14)
    v_mul_f32 v58, v30, v32
    v_mul_f32 v59, v30, v33
    v_mul_f32 v60, v34, v36
    v_mul_f32 v61, v34, v37
    v_mul_f32 v62, v38, v40
    v_mul_f32 v63, v38, v41
    v_fma_f32 v58, -v31, v33, v58
    v_fma_f32 v59, -v31, v32, -v59
    v_fma_f32 v60, -v35, v37, v60
    v_fma_f32 v61, v35, v36, v61
    v_fma_f32 v62, -v39, v41, v62
    v_fma_f32 v63, v39, v40, v63
    v_perm_b32 v105, v43, v42, s25
    v_and_b32 v72, v159, v42
    v_and_b32 v73, v159, v43
    v_perm_b32 v81, v59, v58, s25
    v_and_b32 v66, v159, v58
    v_and_b32 v67, v159, v59
    v_perm_b32 v89, v61, v60, s25
    v_and_b32 v68, v159, v60
    v_and_b32 v69, v159, v61
    v_perm_b32 v97, v63, v62, s25
    v_and_b32 v70, v159, v62
    v_and_b32 v71, v159, v63
    v_sub_f32 v72, v42, v72
    v_sub_f32 v73, v43, v73
    v_sub_f32 v66, v58, v66
    v_sub_f32 v67, v59, v67
    v_sub_f32 v68, v60, v68
    v_sub_f32 v69, v61, v69
    v_sub_f32 v70, v62, v70
    v_sub_f32 v71, v63, v71
    v_perm_b32 v109, v73, v72, s25
    v_perm_b32 v85, v67, v66, s25
    v_perm_b32 v93, v69, v68, s25
    v_perm_b32 v101, v71, v70, s25
    ds_read_b64 v[30:31], v144 offset:1056
    ds_read_b64 v[32:33], v145 offset:1056
    ds_read_b64 v[34:35], v146 offset:1056
    ds_read_b64 v[36:37], v147 offset:1056
    ds_read_b64 v[38:39], v148 offset:1056
    ds_read_b64 v[40:41], v149 offset:1056
    ds_read_b64 v[42:43], v150 offset:1056
    s_waitcnt lgkmcnt(14)
    s_cmp_lg_u32 s15, 0
    s_cbranch_scc1 K12_CP1_END
    s_cmp_lg_u32 s6, 0
    s_cbranch_scc1 K12_CP1_LDS
    s_waitcnt vmcnt(0)
    v_cmp_ne_u32 vcc, s68, v206
    s_cbranch_vccz K12_CP1_GO
    global_load_dword v206, v151, s[64:65] sc1
    s_branch K12_CP1_END
K12_CP1_GO:
    v_mov_b32 v7, 1
    ds_write_b32 v158, v7
    s_branch K12_CP1_LD
K12_CP1_LDS:
    ds_read_b32 v7, v158
    s_waitcnt lgkmcnt(0)
    v_readfirstlane_b32 s13, v7
    s_nop 0
    s_cmp_eq_u32 s13, 0
    s_cbranch_scc1 K12_CP1_END
K12_CP1_LD:
    global_load_dwordx4 v[196:199], v156, s[16:17] sc1
    global_load_dwordx4 v[208:211], v157, s[64:65] offset:0 sc1
    global_load_dwordx4 v[212:215], v157, s[64:65] offset:16 sc1
    global_load_dwordx4 v[216:219], v157, s[64:65] offset:32 sc1
    global_load_dwordx4 v[220:223], v157, s[64:65] offset:48 sc1
    s_mov_b32 s15, 1
K12_CP1_END:
    s_waitcnt lgkmcnt(0)
    v_mul_f32 v58, v44, v46
    v_mul_f32 v59, v44, v47
    v_mul_f32 v60, v48, v50
    v_mul_f32 v61, v48, v51
    v_mul_f32 v62, v52, v54
    v_mul_f32 v63, v52, v55
    v_fma_f32 v58, -v45, v47, v58
    v_fma_f32 v59, -v45, v46, -v59
    v_fma_f32 v60, -v49, v51, v60
    v_fma_f32 v61, v49, v50, v61
    v_fma_f32 v62, -v53, v55, v62
    v_fma_f32 v63, v53, v54, v63
    v_perm_b32 v106, v57, v56, s25
    v_and_b32 v72, v159, v56
    v_and_b32 v73, v159, v57
    v_perm_b32 v82, v59, v58, s25
    v_and_b32 v66, v159, v58
    v_and_b32 v67, v159, v59
    v_perm_b32 v90, v61, v60, s25
    v_and_b32 v68, v159, v60
    v_and_b32 v69, v159, v61
    v_perm_b32 v98, v63, v62, s25
    v_and_b32 v70, v159, v62
    v_and_b32 v71, v159, v63
    v_sub_f32 v72, v56, v72
    v_sub_f32 v73, v57, v73
    v_sub_f32 v66, v58, v66
    v_sub_f32 v67, v59, v67
    v_sub_f32 v68, v60, v68
    v_sub_f32 v69, v61, v69
    v_sub_f32 v70, v62, v70
    v_sub_f32 v71, v63, v71
    v_perm_b32 v110, v73, v72, s25
    v_perm_b32 v86, v67, v66, s25
    v_perm_b32 v94, v69, v68, s25
    v_perm_b32 v102, v71, v70, s25
    ds_read_b64 v[44:45], v144 offset:1320
    ds_read_b64 v[46:47], v145 offset:1320
    ds_read_b64 v[48:49], v146 offset:1320
    ds_read_b64 v[50:51], v147 offset:1320
    ds_read_b64 v[52:53], v148 offset:1320
    ds_read_b64 v[54:55], v149 offset:1320
    ds_read_b64 v[56:57], v150 offset:1320
    s_waitcnt lgkmcnt(14)
    v_mul_f32 v58, v16, v18
    v_mul_f32 v59, v16, v19
    v_mul_f32 v60, v20, v22
    v_mul_f32 v61, v20, v23
    v_mul_f32 v62, v24, v26
    v_mul_f32 v63, v24, v27
    v_fma_f32 v58, -v17, v19, v58
    v_fma_f32 v59, -v17, v18, -v59
    v_fma_f32 v60, -v21, v23, v60
    v_fma_f32 v61, v21, v22, v61
    v_fma_f32 v62, -v25, v27, v62
    v_fma_f32 v63, v25, v26, v63
    v_perm_b32 v107, v29, v28, s25
    v_and_b32 v72, v159, v28
    v_and_b32 v73, v159, v29
    v_perm_b32 v83, v59, v58, s25
    v_and_b32 v66, v159, v58
    v_and_b32 v67, v159, v59
    v_perm_b32 v91, v61, v60, s25
    v_and_b32 v68, v159, v60
    v_and_b32 v69, v159, v61
    v_perm_b32 v99, v63, v62, s25
    v_and_b32 v70, v159, v62
    v_and_b32 v71, v159, v63
    v_sub_f32 v72, v28, v72
    v_sub_f32 v73, v29, v73
    v_sub_f32 v66, v58, v66
    v_sub_f32 v67, v59, v67
    v_sub_f32 v68, v60, v68
    v_sub_f32 v69, v61, v69
    v_sub_f32 v70, v62, v70
    v_sub_f32 v71, v63, v71
    v_perm_b32 v111, v73, v72, s25
    v_perm_b32 v87, v67, v66, s25
    v_perm_b32 v95, v69, v68, s25
    v_perm_b32 v103, v71, v70, s25
    s_cmp_lg_u32 s15, 0
    s_cbranch_scc1 K12_CP2_END
    s_cmp_lg_u32 s6, 0
    s_cbranch_scc1 K12_CP2_LDS
    s_waitcnt vmcnt(0)
    v_cmp_ne_u32 vcc, s68, v206
    s_cbranch_vccz K12_CP2_GO
    global_load_dword v206, v151, s[64:65] sc1
    s_branch K12_CP2_END
K12_CP2_GO:
    v_mov_b32 v7, 1
    ds_write_b32 v158, v7
    s_branch K12_CP2_LD
K12_CP2_LDS:
    ds_read_b32 v7, v158
    s_waitcnt lgkmcnt(0)
    v_readfirstlane_b32 s13, v7
    s_nop 0
    s_cmp_eq_u32 s13, 0
    s_cbranch_scc1 K12_CP2_END
K12_CP2_LD:
    global_load_dwordx4 v[196:199], v156, s[16:17] sc1
    global_load_dwordx4 v[208:211], v157, s[64:65] offset:0 sc1
    global_load_dwordx4 v[212:215], v157, s[64:65] offset:16 sc1
    global_load_dwordx4 v[216:219], v157, s[64:65] offset:32 sc1
    global_load_dwordx4 v[220:223], v157, s[64:65] offset:48 sc1
    s_mov_b32 s15, 1
K12_CP2_END:
    s_waitcnt lgkmcnt(0)
    ds_read_b64 v[16:17], v144 offset:1584
    ds_read_b64 v[18:19], v145 offset:1584
    ds_read_b64 v[20:21], v146 offset:1584
    ds_read_b64 v[22:23], v147 offset:1584
    ds_read_b64 v[24:25], v148 offset:1584
    ds_read_b64 v[26:27], v149 offset:1584
    ds_read_b64 v[28:29], v150 offset:1584
    s_waitcnt lgkmcnt(14)
    v_mul_f32 v58, v30, v32
    v_mul_f32 v59, v30, v33
    v_mul_f32 v60, v34, v36
    v_mul_f32 v61, v34, v37
    v_mul_f32 v62, v38, v40
    v_mul_f32 v63, v38, v41
    v_fma_f32 v58, -v31, v33, v58
    v_fma_f32 v59, -v31, v32, -v59
    v_fma_f32 v60, -v35, v37, v60
    v_fma_f32 v61, v35, v36, v61
    v_fma_f32 v62, -v39, v41, v62
    v_fma_f32 v63, v39, v40, v63
    v_perm_b32 v136, v43, v42, s25
    v_and_b32 v72, v159, v42
    v_and_b32 v73, v159, v43
    v_perm_b32 v112, v59, v58, s25
    v_and_b32 v66, v159, v58
    v_mfma_f32_16x16x32_bf16 v[160:163], v[88:91], v[80:83], v[160:163]
    v_and_b32 v67, v159, v59
    v_perm_b32 v120, v61, v60, s25
    v_and_b32 v68, v159, v60
    v_and_b32 v69, v159, v61
    v_perm_b32 v128, v63, v62, s25
    v_and_b32 v70, v159, v62
    v_and_b32 v71, v159, v63
    v_sub_f32 v72, v42, v72
    v_sub_f32 v73, v43, v73
    v_sub_f32 v66, v58, v66
    v_sub_f32 v67, v59, v67
    v_sub_f32 v68, v60, v68
    v_sub_f32 v69, v61, v69
    v_sub_f32 v70, v62, v70
    v_sub_f32 v71, v63, v71
    v_perm_b32 v140, v73, v72, s25
    v_perm_b32 v116, v67, v66, s25
    v_mfma_f32_16x16x32_bf16 v[160:163], v[88:91], v[84:87], v[160:163]
    v_perm_b32 v124, v69, v68, s25
    v_perm_b32 v132, v71, v70, s25
    ds_read_b64 v[30:31], v144 offset:1848
    ds_read_b64 v[32:33], v145 offset:1848
    ds_read_b64 v[34:35], v146 offset:1848
    ds_read_b64 v[36:37], v147 offset:1848
    ds_read_b64 v[38:39], v148 offset:1848
    ds_read_b64 v[40:41], v149 offset:1848
    ds_read_b64 v[42:43], v150 offset:1848
    s_waitcnt lgkmcnt(14)
    v_mul_f32 v58, v44, v46
    v_mul_f32 v59, v44, v47
    v_mul_f32 v60, v48, v50
    v_mul_f32 v61, v48, v51
    v_mul_f32 v62, v52, v54
    v_mul_f32 v63, v52, v55
    v_fma_f32 v58, -v45, v47, v58
    v_mfma_f32_16x16x32_bf16 v[160:163], v[92:95], v[80:83], v[160:163]
    v_fma_f32 v59, -v45, v46, -v59
    v_fma_f32 v60, -v49, v51, v60
    v_fma_f32 v61, v49, v50, v61
    v_fma_f32 v62, -v53, v55, v62
    v_fma_f32 v63, v53, v54, v63
    v_perm_b32 v137, v57, v56, s25
    v_and_b32 v72, v159, v56
    v_and_b32 v73, v159, v57
    v_perm_b32 v113, v59, v58, s25
    v_and_b32 v66, v159, v58
    v_and_b32 v67, v159, v59
    v_perm_b32 v121, v61, v60, s25
    v_and_b32 v68, v159, v60
    v_and_b32 v69, v159, v61
    v_perm_b32 v129, v63, v62, s25
    v_and_b32 v70, v159, v62
    v_and_b32 v71, v159, v63
    v_mfma_f32_16x16x32_bf16 v[164:167], v[96:99], v[80:83], v[164:167]
    v_sub_f32 v72, v56, v72
    v_sub_f32 v73, v57, v73
    v_sub_f32 v66, v58, v66
    v_sub_f32 v67, v59, v67
    v_sub_f32 v68, v60, v68
    v_sub_f32 v69, v61, v69
    v_sub_f32 v70, v62, v70
    v_sub_f32 v71, v63, v71
    v_perm_b32 v141, v73, v72, s25
    v_perm_b32 v117, v67, v66, s25
    v_perm_b32 v125, v69, v68, s25
    v_perm_b32 v133, v71, v70, s25
    s_waitcnt lgkmcnt(7)
    s_cmp_lg_u32 s15, 0
    s_cbranch_scc1 K12_CP3_END
    s_cmp_lg_u32 s6, 0
    s_cbranch_scc1 K12_CP3_LDS
    s_waitcnt vmcnt(0)
    v_cmp_ne_u32 vcc, s68, v206
    s_cbranch_vccz K12_CP3_GO
    global_load_dword v206, v151, s[64:65] sc1
    s_branch K12_CP3_END
K12_CP3_GO:
    v_mov_b32 v7, 1
    ds_write_b32 v158, v7
    s_branch K12_CP3_LD
K12_CP3_LDS:
    ds_read_b32 v7, v158
    s_waitcnt lgkmcnt(0)
    v_readfirstlane_b32 s13, v7
    s_nop 0
    s_cmp_eq_u32 s13, 0
    s_cbranch_scc1 K12_CP3_END
K12_CP3_LD:
    global_load_dwordx4 v[196:199], v156, s[16:17] sc1
    global_load_dwordx4 v[208:211], v157, s[64:65] offset:0 sc1
    global_load_dwordx4 v[212:215], v157, s[64:65] offset:16 sc1
    global_load_dwordx4 v[216:219], v157, s[64:65] offset:32 sc1
    global_load_dwordx4 v[220:223], v157, s[64:65] offset:48 sc1
    s_mov_b32 s15, 1
K12_CP3_END:
    s_waitcnt lgkmcnt(0)
    v_mul_f32 v58, v16, v18
    v_mul_f32 v59, v16, v19
    v_mul_f32 v60, v20, v22
    v_mfma_f32_16x16x32_bf16 v[164:167], v[96:99], v[84:87], v[164:167]
    v_mul_f32 v61, v20, v23
    v_mul_f32 v62, v24, v26
    v_mul_f32 v63, v24, v27
    v_fma_f32 v58, -v17, v19, v58
    v_fma_f32 v59, -v17, v18, -v59
    v_fma_f32 v60, -v21, v23, v60
    v_fma_f32 v61, v21, v22, v61
    v_fma_f32 v62, -v25, v27, v62
    v_fma_f32 v63, v25, v26, v63
    v_perm_b32 v138, v29, v28, s25
    v_and_b32 v72, v159, v28
    v_and_b32 v73, v159, v29
    v_perm_b32 v114, v59, v58, s25
    v_and_b32 v66, v159, v58
    v_and_b32 v67, v159, v59
    v_perm_b32 v122, v61, v60, s25
    v_and_b32 v68, v159, v60
    v_mfma_f32_16x16x32_bf16 v[164:167], v[100:103], v[80:83], v[164:167]
    v_and_b32 v69, v159, v61
    v_perm_b32 v130, v63, v62, s25
    v_and_b32 v70, v159, v62
    v_and_b32 v71, v159, v63
    v_sub_f32 v72, v28, v72
    v_sub_f32 v73, v29, v73
    v_sub_f32 v66, v58, v66
    v_sub_f32 v67, v59, v67
    v_sub_f32 v68, v60, v68
    v_sub_f32 v69, v61, v69
    v_sub_f32 v70, v62, v70
    v_sub_f32 v71, v63, v71
    v_perm_b32 v142, v73, v72, s25
    v_perm_b32 v118, v67, v66, s25
    v_perm_b32 v126, v69, v68, s25
    v_perm_b32 v134, v71, v70, s25
    s_waitcnt lgkmcnt(0)
    v_mfma_f32_16x16x32_bf16 v[168:171], v[104:107], v[80:83], v[168:171]
    v_mul_f32 v58, v30, v32
    v_mul_f32 v59, v30, v33
    v_mul_f32 v60, v34, v36
    v_mul_f32 v61, v34, v37
    v_mul_f32 v62, v38, v40
    v_mul_f32 v63, v38, v41
    v_fma_f32 v58, -v31, v33, v58
    v_fma_f32 v59, -v31, v32, -v59
    v_fma_f32 v60, -v35, v37, v60
    v_fma_f32 v61, v35, v36, v61
    v_fma_f32 v62, -v39, v41, v62
    v_fma_f32 v63, v39, v40, v63
    v_perm_b32 v139, v43, v42, s25
    v_and_b32 v72, v159, v42
    v_and_b32 v73, v159, v43
    v_perm_b32 v115, v59, v58, s25
    v_and_b32 v66, v159, v58
    v_mfma_f32_16x16x32_bf16 v[168:171], v[104:107], v[84:87], v[168:171]
    v_and_b32 v67, v159, v59
    v_perm_b32 v123, v61, v60, s25
    v_and_b32 v68, v159, v60
    v_and_b32 v69, v159, v61
    v_perm_b32 v131, v63, v62, s25
    v_and_b32 v70, v159, v62
    v_and_b32 v71, v159, v63
    v_sub_f32 v72, v42, v72
    v_sub_f32 v73, v43, v73
    v_sub_f32 v66, v58, v66
    v_sub_f32 v67, v59, v67
    v_sub_f32 v68, v60, v68
    v_sub_f32 v69, v61, v69
    v_sub_f32 v70, v62, v70
    v_sub_f32 v71, v63, v71
    v_perm_b32 v143, v73, v72, s25
    v_perm_b32 v119, v67, v66, s25
    v_mfma_f32_16x16x32_bf16 v[168:171], v[108:111], v[80:83], v[168:171]
    v_perm_b32 v127, v69, v68, s25
    v_perm_b32 v135, v71, v70, s25
    v_mfma_f32_16x16x32_bf16 v[160:163], v[120:123], v[112:115], v[160:163]
    v_mfma_f32_16x16x32_bf16 v[160:163], v[120:123], v[116:119], v[160:163]
    v_mfma_f32_16x16x32_bf16 v[160:163], v[124:127], v[112:115], v[160:163]
    v_mfma_f32_16x16x32_bf16 v[164:167], v[128:131], v[112:115], v[164:167]
    v_mfma_f32_16x16x32_bf16 v[164:167], v[128:131], v[116:119], v[164:167]
    v_mfma_f32_16x16x32_bf16 v[164:167], v[132:135], v[112:115], v[164:167]
    v_mfma_f32_16x16x32_bf16 v[168:171], v[136:139], v[112:115], v[168:171]
    v_mfma_f32_16x16x32_bf16 v[168:171], v[136:139], v[116:119], v[168:171]
    v_mfma_f32_16x16x32_bf16 v[168:171], v[140:143], v[112:115], v[168:171]
    s_mov_b32 s14, 0
K12_SPIN:
    s_cmp_lg_u32 s15, 0
    s_cbranch_scc1 K12_CP4_END
    s_cmp_lg_u32 s6, 0
    s_cbranch_scc1 K12_CP4_LDS
    s_waitcnt vmcnt(0)
    v_cmp_ne_u32 vcc, s68, v206
    s_cbranch_vccz K12_CP4_GO
    global_load_dword v206, v151, s[64:65] sc1
    s_branch K12_CP4_END
K12_CP4_GO:
    v_mov_b32 v7, 1
    ds_write_b32 v158, v7
    s_branch K12_CP4_LD
K12_CP4_LDS:
    ds_read_b32 v7, v158
    s_waitcnt lgkmcnt(0)
    v_readfirstlane_b32 s13, v7
    s_nop 0
    s_cmp_eq_u32 s13, 0
    s_cbranch_scc1 K12_CP4_END
K12_CP4_LD:
    global_load_dwordx4 v[196:199], v156, s[16:17] sc1
    global_load_dwordx4 v[208:211], v157, s[64:65] offset:0 sc1
    global_load_dwordx4 v[212:215], v157, s[64:65] offset:16 sc1
    global_load_dwordx4 v[216:219], v157, s[64:65] offset:32 sc1
    global_load_dwordx4 v[220:223], v157, s[64:65] offset:48 sc1
    s_mov_b32 s15, 1
K12_CP4_END:
    s_waitcnt lgkmcnt(0)
    s_cmp_lg_u32 s15, 0
    s_cbranch_scc1 K12_LDDONE
    s_sleep 2
    s_add_u32 s14, s14, 1
    s_cmp_lt_u32 s14, 50000
    s_cbranch_scc1 K12_SPIN
K12_LDDONE:
    s_mul_i32 s7, s6, 3072
    s_add_u32 s7, s7, 115200
    v_lshlrev_b32 v9, 2, v2
    v_add_u32 v10, s7, v9
    ds_write_b32 v10, v160 offset:0
    ds_write_b32 v10, v161 offset:256
    ds_write_b32 v10, v162 offset:512
    ds_write_b32 v10, v163 offset:768
    ds_write_b32 v10, v164 offset:1024
    ds_write_b32 v10, v165 offset:1280
    ds_write_b32 v10, v166 offset:1536
    ds_write_b32 v10, v167 offset:1792
    ds_write_b32 v10, v168 offset:2048
    ds_write_b32 v10, v169 offset:2304
    ds_write_b32 v10, v170 offset:2560
    ds_write_b32 v10, v171 offset:2816
    v_mov_b32 v3, v155
    v_mov_b32 v4, v156
    s_mul_i32 s7, s8, 4224
    s_add_u32 s7, s7, 92160
    v_add_u32 v5, s7, v4
    v_mov_b32 v24, 0
    v_mov_b32 v25, 0
    v_mov_b32 v26, 0
    v_mov_b32 v27, 0
    v_cmp_gt_u32 vcc, 2, v3
    s_nop 0
    s_and_saveexec_b64 s[28:29], vcc
    ds_write_b128 v5, v[24:27]
    ds_write_b128 v5, v[24:27] offset:4128
    s_mov_b64 exec, s[28:29]
    s_waitcnt vmcnt(0)
    v_lshlrev_b32 v44, 16, v196
    v_and_b32 v45, s24, v196
    v_sub_f32 v44, v44, v208
    v_sub_f32 v45, v45, v210
    v_cvt_pk_bf16_f32 v46, v44, v45
    v_lshlrev_b32 v44, 16, v46
    v_and_b32 v45, s24, v46
    v_mul_f32 v44, v44, v209
    v_mul_f32 v45, v45, v211
    v_cvt_pk_bf16_f32 v192, v44, v45
    v_lshlrev_b32 v47, 16, v197
    v_and_b32 v48, s24, v197
    v_sub_f32 v47, v47, v212
    v_sub_f32 v48, v48, v214
    v_cvt_pk_bf16_f32 v49, v47, v48
    v_lshlrev_b32 v47, 16, v49
    v_and_b32 v48, s24, v49
    v_mul_f32 v47, v47, v213
    v_mul_f32 v48, v48, v215
    v_cvt_pk_bf16_f32 v193, v47, v48
    v_lshlrev_b32 v44, 16, v198
    v_and_b32 v45, s24, v198
    v_sub_f32 v44, v44, v216
    v_sub_f32 v45, v45, v218
    v_cvt_pk_bf16_f32 v46, v44, v45
    v_lshlrev_b32 v44, 16, v46
    v_and_b32 v45, s24, v46
    v_mul_f32 v44, v44, v217
    v_mul_f32 v45, v45, v219
    v_cvt_pk_bf16_f32 v194, v44, v45
    v_lshlrev_b32 v47, 16, v199
    v_and_b32 v48, s24, v199
    v_sub_f32 v47, v47, v220
    v_sub_f32 v48, v48, v222
    v_cvt_pk_bf16_f32 v49, v47, v48
    v_lshlrev_b32 v47, 16, v49
    v_and_b32 v48, s24, v49
    v_mul_f32 v47, v47, v221
    v_mul_f32 v48, v48, v223
    v_cvt_pk_bf16_f32 v195, v47, v48
    ds_write_b128 v5, v[192:195] offset:32
    v_lshlrev_b32 v10, 3, v3
    v_sub_u32 v10, 0x7ff, v10
    v_subrev_u32 v44, 0, v10
    v_cvt_f32_u32 v52, v44
    v_cvt_pk_bf16_f32 v52, v52, v52
    v_and_b32 v52, 0xffff, v52
    v_subrev_u32 v52, 0x4280, v52
    v_med3_i32 v52, v52, v44, s12
    v_lshlrev_b32 v52, 2, v52
    v_add_u32 v52, s11, v52
    v_subrev_u32 v45, 1, v10
    v_cvt_f32_u32 v53, v45
    v_cvt_pk_bf16_f32 v53, v53, v53
    v_and_b32 v53, 0xffff, v53
    v_subrev_u32 v53, 0x4280, v53
    v_med3_i32 v53, v53, v45, s12
    v_lshlrev_b32 v53, 2, v53
    v_add_u32 v53, s11, v53
    v_subrev_u32 v46, 2, v10
    v_cvt_f32_u32 v54, v46
    v_cvt_pk_bf16_f32 v54, v54, v54
    v_and_b32 v54, 0xffff, v54
    v_subrev_u32 v54, 0x4280, v54
    v_med3_i32 v54, v54, v46, s12
    v_lshlrev_b32 v54, 2, v54
    v_add_u32 v54, s11, v54
    v_subrev_u32 v47, 3, v10
    v_cvt_f32_u32 v55, v47
    v_cvt_pk_bf16_f32 v55, v55, v55
    v_and_b32 v55, 0xffff, v55
    v_subrev_u32 v55, 0x4280, v55
    v_med3_i32 v55, v55, v47, s12
    v_lshlrev_b32 v55, 2, v55
    v_add_u32 v55, s11, v55
    v_subrev_u32 v48, 4, v10
    v_cvt_f32_u32 v56, v48
    v_cvt_pk_bf16_f32 v56, v56, v56
    v_and_b32 v56, 0xffff, v56
    v_subrev_u32 v56, 0x4280, v56
    v_med3_i32 v56, v56, v48, s12
    v_lshlrev_b32 v56, 2, v56
    v_add_u32 v56, s11, v56
    v_subrev_u32 v49, 5, v10
    v_cvt_f32_u32 v57, v49
    v_cvt_pk_bf16_f32 v57, v57, v57
    v_and_b32 v57, 0xffff, v57
    v_subrev_u32 v57, 0x4280, v57
    v_med3_i32 v57, v57, v49, s12
    v_lshlrev_b32 v57, 2, v57
    v_add_u32 v57, s11, v57
    v_subrev_u32 v50, 6, v10
    v_cvt_f32_u32 v58, v50
    v_cvt_pk_bf16_f32 v58, v58, v58
    v_and_b32 v58, 0xffff, v58
    v_subrev_u32 v58, 0x4280, v58
    v_med3_i32 v58, v58, v50, s12
    v_lshlrev_b32 v58, 2, v58
    v_add_u32 v58, s11, v58
    v_subrev_u32 v51, 7, v10
    v_cvt_f32_u32 v59, v51
    v_cvt_pk_bf16_f32 v59, v59, v59
    v_and_b32 v59, 0xffff, v59
    v_subrev_u32 v59, 0x4280, v59
    v_med3_i32 v59, v59, v51, s12
    v_lshlrev_b32 v59, 2, v59
    v_add_u32 v59, s11, v59
    s_waitcnt lgkmcnt(0)
    s_barrier
    s_mul_i32 s7, s8, 12288
    s_lshl_b32 s13, s9, 8
    s_add_u32 s7, s7, s13
    s_add_u32 s7, s7, 115200
    v_add_u32 v9, s7, v9
    ds_read_b32 v80, v9 offset:0
    ds_read_b32 v81, v9 offset:3072
    ds_read_b32 v82, v9 offset:6144
    ds_read_b32 v83, v9 offset:9216
    ds_read_b32 v84, v9 offset:1024
    ds_read_b32 v85, v9 offset:4096
    ds_read_b32 v86, v9 offset:7168
    ds_read_b32 v87, v9 offset:10240
    ds_read_b32 v88, v9 offset:2048
    ds_read_b32 v89, v9 offset:5120
    ds_read_b32 v90, v9 offset:8192
    ds_read_b32 v91, v9 offset:11264
    v_add_u32 v6, s10, v4
    v_mov_b32 v24, 0
    v_mov_b32 v25, 0
    v_mov_b32 v26, 0
    v_mov_b32 v27, 0
    v_cmp_gt_u32 vcc, 32, v3
    s_nop 0
    s_and_saveexec_b64 s[28:29], vcc
    ds_write_b128 v6, v[24:27] offset:4096
    ds_write_b128 v6, v[24:27] offset:8704
    s_mov_b64 exec, s[28:29]
    ds_read_b128 v[16:19], v5
    ds_read_b128 v[20:23], v5 offset:16
    ds_read_b128 v[208:211], v5 offset:4096
    ds_read_b128 v[212:215], v5 offset:4112
    s_waitcnt lgkmcnt(0)
    v_add_f32 v80, v80, v81
    v_add_f32 v82, v82, v83
    v_add_f32 v80, v80, v82
    ds_write_b32 v152, v80
    v_add_f32 v84, v84, v85
    v_add_f32 v86, v86, v87
    v_add_f32 v84, v84, v86
    ds_write_b32 v153, v84
    v_add_f32 v88, v88, v89
    v_add_f32 v90, v90, v91
    v_add_f32 v88, v88, v90
    ds_write_b32 v154, v88
    v_mov_b32 v24, v17
    v_mov_b32 v25, v18
    v_mov_b32 v26, v19
    v_mov_b32 v27, v20
    v_alignbyte_b32 v30, v17, v16, 2
    v_alignbyte_b32 v31, v18, v17, 2
    v_alignbyte_b32 v32, v19, v18, 2
    v_alignbyte_b32 v33, v20, v19, 2
    v_alignbyte_b32 v38, v18, v17, 2
    v_alignbyte_b32 v39, v19, v18, 2
    v_alignbyte_b32 v40, v20, v19, 2
    v_alignbyte_b32 v41, v21, v20, 2
    ds_write_b128 v6, v[16:19] offset:9216
    ds_write_b128 v6, v[30:33] offset:13632
    ds_write_b128 v6, v[24:27] offset:18032
    ds_write_b128 v6, v[38:41] offset:22432
    s_cmp_lg_u32 s9, 0
    s_cbranch_scc1 K12_NOC2
    v_cmp_gt_u32 vcc, 2, v3
    s_nop 0
    s_and_saveexec_b64 s[28:29], vcc
    v_mov_b32 v24, v209
    v_mov_b32 v25, v210
    v_mov_b32 v26, v211
    v_mov_b32 v27, v212
    v_alignbyte_b32 v30, v209, v208, 2
    v_alignbyte_b32 v31, v210, v209, 2
    v_alignbyte_b32 v32, v211, v210, 2
    v_alignbyte_b32 v33, v212, v211, 2
    v_alignbyte_b32 v38, v210, v209, 2
    v_alignbyte_b32 v39, v211, v210, 2
    v_alignbyte_b32 v40, v212, v211, 2
    v_alignbyte_b32 v41, v213, v212, 2
    ds_write_b128 v6, v[208:211] offset:13312
    ds_write_b128 v6, v[30:33] offset:17728
    ds_write_b128 v6, v[24:27] offset:22128
    ds_write_b128 v6, v[38:41] offset:26528
    s_mov_b64 exec, s[28:29]
K12_NOC2:
    s_waitcnt lgkmcnt(0)
    s_barrier
    ds_read_b32 v60, v52
    ds_read_b32 v61, v53
    ds_read_b32 v62, v54
    ds_read_b32 v63, v55
    ds_read_b32 v64, v56
    ds_read_b32 v65, v57
    ds_read_b32 v66, v58
    ds_read_b32 v67, v59
    v_and_b32 v7, 15, v2
    v_lshrrev_b32 v8, 4, v2
    v_lshlrev_b32 v9, 5, v7
    v_lshlrev_b32 v10, 4, v8
    v_sub_u32 v9, v10, v9
    s_lshl_b32 s7, s9, 6
    s_sub_u32 s14, s10, s7
    s_add_u32 s13, s14, 928
    v_add_u32 v9, s13, v9
    v_add_u32 v11, 1, v7
    v_and_b32 v12, 3, v11
    v_lshrrev_b32 v13, 2, v11
    v_lshl_add_u32 v13, v8, 1, v13
    v_lshlrev_b32 v13, 3, v13
    v_lshlrev_b32 v14, 3, v12
    s_mov_b32 s13, 0xa0704000
    v_lshrrev_b32 v14, v14, s13
    v_and_b32 v14, 0xff, v14
    v_add_u32 v13, v13, v14
    s_movk_i32 s13, 4352
    v_mul_lo_u32 v12, v12, s13
    v_add_u32 v13, v13, v12
    s_add_u32 s13, s14, 9664
    v_add_u32 v10, s13, v13
    s_waitcnt lgkmcnt(0)
    v_cvt_pk_bf16_f32 v68, v60, v61
    v_lshlrev_b32 v76, 16, v68
    v_and_b32 v77, s24, v68
    v_sub_f32 v76, v60, v76
    v_sub_f32 v77, v61, v77
    v_cvt_pk_bf16_f32 v72, v76, v77
    v_cvt_pk_bf16_f32 v69, v62, v63
    v_lshlrev_b32 v76, 16, v69
    v_and_b32 v77, s24, v69
    v_sub_f32 v76, v62, v76
    v_sub_f32 v77, v63, v77
    v_cvt_pk_bf16_f32 v73, v76, v77
    v_cvt_pk_bf16_f32 v70, v64, v65
    v_lshlrev_b32 v76, 16, v70
    v_and_b32 v77, s24, v70
    v_sub_f32 v76, v64, v76
    v_sub_f32 v77, v65, v77
    v_cvt_pk_bf16_f32 v74, v76, v77
    v_cvt_pk_bf16_f32 v71, v66, v67
    v_lshlrev_b32 v76, 16, v71
    v_and_b32 v77, s24, v71
    v_sub_f32 v76, v66, v76
    v_sub_f32 v77, v67, v77
    v_cvt_pk_bf16_f32 v75, v76, v77
    ds_write_b128 v6, v[68:71]
    ds_write_b128 v6, v[72:75] offset:4608
    v_mov_b32 v160, 0
    v_mov_b32 v161, 0
    v_mov_b32 v162, 0
    v_mov_b32 v163, 0
    v_mov_b32 v164, 0
    v_mov_b32 v165, 0
    v_mov_b32 v166, 0
    v_mov_b32 v167, 0
    v_mov_b32 v168, 0
    v_mov_b32 v169, 0
    v_mov_b32 v170, 0
    v_mov_b32 v171, 0
    v_mov_b32 v172, 0
    v_mov_b32 v173, 0
    v_mov_b32 v174, 0
    v_mov_b32 v175, 0
    v_mov_b32 v176, 0
    v_mov_b32 v177, 0
    v_mov_b32 v178, 0
    v_mov_b32 v179, 0
    v_mov_b32 v180, 0
    v_mov_b32 v181, 0
    v_mov_b32 v182, 0
    v_mov_b32 v183, 0
    v_mov_b32 v184, 0
    v_mov_b32 v185, 0
    v_mov_b32 v186, 0
    v_mov_b32 v187, 0
    v_mov_b32 v188, 0
    v_mov_b32 v189, 0
    v_mov_b32 v190, 0
    v_mov_b32 v191, 0
    s_waitcnt lgkmcnt(0)
    s_barrier
    ds_read_b64 v[128:129], v10 offset:0
    ds_read_b64 v[130:131], v10 offset:8
    ds_read_b128 v[64:67], v9 offset:3584
    ds_read_b128 v[68:71], v9 offset:8192
    ds_read_b64 v[132:133], v10 offset:512
    ds_read_b64 v[134:135], v10 offset:520
    ds_read_b128 v[72:75], v9 offset:3072
    ds_read_b128 v[76:79], v9 offset:7680
    ds_read_b64 v[136:137], v10 offset:1024
    ds_read_b64 v[138:139], v10 offset:1032
    ds_read_b128 v[80:83], v9 offset:2560
    ds_read_b128 v[84:87], v9 offset:7168
    ds_read_b64 v[140:141], v10 offset:1536
    ds_read_b64 v[142:143], v10 offset:1544
    ds_read_b128 v[88:91], v9 offset:2048
    ds_read_b128 v[92:95], v9 offset:6656
    ds_read_b64 v[144:145], v10 offset:2048
    ds_read_b64 v[146:147], v10 offset:2056
    ds_read_b128 v[96:99], v9 offset:1536
    ds_read_b128 v[100:103], v9 offset:6144
    ds_read_b64 v[148:149], v10 offset:2560
    ds_read_b64 v[150:151], v10 offset:2568
    ds_read_b128 v[104:107], v9 offset:1024
    ds_read_b128 v[108:111], v9 offset:5632
    ds_read_b64 v[152:153], v10 offset:3072
    ds_read_b64 v[154:155], v10 offset:3080
    ds_read_b128 v[112:115], v9 offset:512
    ds_read_b128 v[116:119], v9 offset:5120
    ds_read_b64 v[156:157], v10 offset:3584
    ds_read_b64 v[158:159], v10 offset:3592
    ds_read_b128 v[120:123], v9 offset:0
    ds_read_b128 v[124:127], v9 offset:4608
    s_waitcnt lgkmcnt(15)
    v_mfma_f32_16x16x32_bf16 v[160:163], v[64:67], v[128:131], v[160:163]
    v_mfma_f32_16x16x32_bf16 v[160:163], v[68:71], v[128:131], v[160:163]
    s_waitcnt lgkmcnt(15)
    v_mfma_f32_16x16x32_bf16 v[164:167], v[72:75], v[128:131], v[164:167]
    v_mfma_f32_16x16x32_bf16 v[164:167], v[76:79], v[128:131], v[164:167]
    v_mfma_f32_16x16x32_bf16 v[168:171], v[72:75], v[132:135], v[168:171]
    v_mfma_f32_16x16x32_bf16 v[168:171], v[76:79], v[132:135], v[168:171]
    v_mfma_f32_16x16x32_bf16 v[164:167], v[64:67], v[132:135], v[164:167]
    v_mfma_f32_16x16x32_bf16 v[164:167], v[68:71], v[132:135], v[164:167]
    s_waitcnt lgkmcnt(15)
    v_mfma_f32_16x16x32_bf16 v[168:171], v[80:83], v[128:131], v[168:171]
    v_mfma_f32_16x16x32_bf16 v[168:171], v[84:87], v[128:131], v[168:171]
    v_mfma_f32_16x16x32_bf16 v[172:175], v[80:83], v[132:135], v[172:175]
    v_mfma_f32_16x16x32_bf16 v[172:175], v[84:87], v[132:135], v[172:175]
    v_mfma_f32_16x16x32_bf16 v[176:179], v[80:83], v[136:139], v[176:179]
    v_mfma_f32_16x16x32_bf16 v[176:179], v[84:87], v[136:139], v[176:179]
    v_mfma_f32_16x16x32_bf16 v[168:171], v[64:67], v[136:139], v[168:171]
    v_mfma_f32_16x16x32_bf16 v[168:171], v[68:71], v[136:139], v[168:171]
    v_mfma_f32_16x16x32_bf16 v[172:175], v[72:75], v[136:139], v[172:175]
    v_mfma_f32_16x16x32_bf16 v[172:175], v[76:79], v[136:139], v[172:175]
    s_waitcnt lgkmcnt(15)
    v_mfma_f32_16x16x32_bf16 v[172:175], v[88:91], v[128:131], v[172:175]
    v_mfma_f32_16x16x32_bf16 v[172:175], v[92:95], v[128:131], v[172:175]
    v_mfma_f32_16x16x32_bf16 v[176:179], v[88:91], v[132:135], v[176:179]
    v_mfma_f32_16x16x32_bf16 v[176:179], v[92:95], v[132:135], v[176:179]
    v_mfma_f32_16x16x32_bf16 v[180:183], v[88:91], v[136:139], v[180:183]
    v_mfma_f32_16x16x32_bf16 v[180:183], v[92:95], v[136:139], v[180:183]
    v_mfma_f32_16x16x32_bf16 v[184:187], v[88:91], v[140:143], v[184:187]
    v_mfma_f32_16x16x32_bf16 v[184:187], v[92:95], v[140:143], v[184:187]
    v_mfma_f32_16x16x32_bf16 v[172:175], v[64:67], v[140:143], v[172:175]
    v_mfma_f32_16x16x32_bf16 v[172:175], v[68:71], v[140:143], v[172:175]
    v_mfma_f32_16x16x32_bf16 v[176:179], v[72:75], v[140:143], v[176:179]
    v_mfma_f32_16x16x32_bf16 v[176:179], v[76:79], v[140:143], v[176:179]
    v_mfma_f32_16x16x32_bf16 v[180:183], v[80:83], v[140:143], v[180:183]
    v_mfma_f32_16x16x32_bf16 v[180:183], v[84:87], v[140:143], v[180:183]
    s_waitcnt lgkmcnt(12)
    v_mfma_f32_16x16x32_bf16 v[176:179], v[96:99], v[128:131], v[176:179]
    v_mfma_f32_16x16x32_bf16 v[176:179], v[100:103], v[128:131], v[176:179]
    v_mfma_f32_16x16x32_bf16 v[180:183], v[96:99], v[132:135], v[180:183]
    v_mfma_f32_16x16x32_bf16 v[180:183], v[100:103], v[132:135], v[180:183]
    v_mfma_f32_16x16x32_bf16 v[184:187], v[96:99], v[136:139], v[184:187]
    v_mfma_f32_16x16x32_bf16 v[184:187], v[100:103], v[136:139], v[184:187]
    v_mfma_f32_16x16x32_bf16 v[188:191], v[96:99], v[140:143], v[188:191]
    v_mfma_f32_16x16x32_bf16 v[188:191], v[100:103], v[140:143], v[188:191]
    v_mfma_f32_16x16x32_bf16 v[176:179], v[64:67], v[144:147], v[176:179]
    v_mfma_f32_16x16x32_bf16 v[176:179], v[68:71], v[144:147], v[176:179]
    v_mfma_f32_16x16x32_bf16 v[180:183], v[72:75], v[144:147], v[180:183]
    v_mfma_f32_16x16x32_bf16 v[180:183], v[76:79], v[144:147], v[180:183]
    v_mfma_f32_16x16x32_bf16 v[184:187], v[80:83], v[144:147], v[184:187]
    v_mfma_f32_16x16x32_bf16 v[184:187], v[84:87], v[144:147], v[184:187]
    v_mfma_f32_16x16x32_bf16 v[188:191], v[88:91], v[144:147], v[188:191]
    v_mfma_f32_16x16x32_bf16 v[188:191], v[92:95], v[144:147], v[188:191]
    s_waitcnt lgkmcnt(8)
    v_mfma_f32_16x16x32_bf16 v[180:183], v[104:107], v[128:131], v[180:183]
    v_mfma_f32_16x16x32_bf16 v[180:183], v[108:111], v[128:131], v[180:183]
    v_mfma_f32_16x16x32_bf16 v[184:187], v[104:107], v[132:135], v[184:187]
    v_mfma_f32_16x16x32_bf16 v[184:187], v[108:111], v[132:135], v[184:187]
    v_mfma_f32_16x16x32_bf16 v[188:191], v[104:107], v[136:139], v[188:191]
    v_mfma_f32_16x16x32_bf16 v[188:191], v[108:111], v[136:139], v[188:191]
    v_mfma_f32_16x16x32_bf16 v[180:183], v[64:67], v[148:151], v[180:183]
    v_mfma_f32_16x16x32_bf16 v[180:183], v[68:71], v[148:151], v[180:183]
    v_mfma_f32_16x16x32_bf16 v[184:187], v[72:75], v[148:151], v[184:187]
    v_mfma_f32_16x16x32_bf16 v[184:187], v[76:79], v[148:151], v[184:187]
    v_mfma_f32_16x16x32_bf16 v[188:191], v[80:83], v[148:151], v[188:191]
    v_mfma_f32_16x16x32_bf16 v[188:191], v[84:87], v[148:151], v[188:191]
    s_waitcnt lgkmcnt(4)
    v_mfma_f32_16x16x32_bf16 v[184:187], v[112:115], v[128:131], v[184:187]
    v_mfma_f32_16x16x32_bf16 v[184:187], v[116:119], v[128:131], v[184:187]
    v_mfma_f32_16x16x32_bf16 v[188:191], v[112:115], v[132:135], v[188:191]
    v_mfma_f32_16x16x32_bf16 v[188:191], v[116:119], v[132:135], v[188:191]
    v_mfma_f32_16x16x32_bf16 v[184:187], v[64:67], v[152:155], v[184:187]
    v_mfma_f32_16x16x32_bf16 v[184:187], v[68:71], v[152:155], v[184:187]
    v_mfma_f32_16x16x32_bf16 v[188:191], v[72:75], v[152:155], v[188:191]
    v_mfma_f32_16x16x32_bf16 v[188:191], v[76:79], v[152:155], v[188:191]
    s_waitcnt lgkmcnt(0)
    v_mfma_f32_16x16x32_bf16 v[188:191], v[120:123], v[128:131], v[188:191]
    v_mfma_f32_16x16x32_bf16 v[188:191], v[124:127], v[128:131], v[188:191]
    v_mfma_f32_16x16x32_bf16 v[188:191], v[64:67], v[156:159], v[188:191]
    v_mfma_f32_16x16x32_bf16 v[188:191], v[68:71], v[156:159], v[188:191]
    v_subrev_u32 v9, 0x100, v9
    v_subrev_u32 v10, 0x100, v10
    ds_read_b64 v[128:129], v10 offset:0
    ds_read_b64 v[130:131], v10 offset:8
    ds_read_b128 v[64:67], v9 offset:3584
    ds_read_b128 v[68:71], v9 offset:8192
    ds_read_b64 v[132:133], v10 offset:512
    ds_read_b64 v[134:135], v10 offset:520
    ds_read_b128 v[72:75], v9 offset:3072
    ds_read_b128 v[76:79], v9 offset:7680
    ds_read_b64 v[136:137], v10 offset:1024
    ds_read_b64 v[138:139], v10 offset:1032
    ds_read_b128 v[80:83], v9 offset:2560
    ds_read_b128 v[84:87], v9 offset:7168
    ds_read_b64 v[140:141], v10 offset:1536
    ds_read_b64 v[142:143], v10 offset:1544
    ds_read_b128 v[88:91], v9 offset:2048
    ds_read_b128 v[92:95], v9 offset:6656
    ds_read_b64 v[144:145], v10 offset:2048
    ds_read_b64 v[146:147], v10 offset:2056
    ds_read_b128 v[96:99], v9 offset:1536
    ds_read_b128 v[100:103], v9 offset:6144
    ds_read_b64 v[148:149], v10 offset:2560
    ds_read_b64 v[150:151], v10 offset:2568
    ds_read_b128 v[104:107], v9 offset:1024
    ds_read_b128 v[108:111], v9 offset:5632
    ds_read_b64 v[152:153], v10 offset:3072
    ds_read_b64 v[154:155], v10 offset:3080
    ds_read_b128 v[112:115], v9 offset:512
    ds_read_b128 v[116:119], v9 offset:5120
    ds_read_b64 v[156:157], v10 offset:3584
    ds_read_b64 v[158:159], v10 offset:3592
    ds_read_b128 v[120:123], v9 offset:0
    ds_read_b128 v[124:127], v9 offset:4608
    s_waitcnt lgkmcnt(15)
    v_mfma_f32_16x16x32_bf16 v[160:163], v[64:67], v[128:131], v[160:163]
    v_mfma_f32_16x16x32_bf16 v[160:163], v[68:71], v[128:131], v[160:163]
    s_waitcnt lgkmcnt(15)
    v_mfma_f32_16x16x32_bf16 v[164:167], v[72:75], v[128:131], v[164:167]
    v_mfma_f32_16x16x32_bf16 v[164:167], v[76:79], v[128:131], v[164:167]
    v_mfma_f32_16x16x32_bf16 v[168:171], v[72:75], v[132:135], v[168:171]
    v_mfma_f32_16x16x32_bf16 v[168:171], v[76:79], v[132:135], v[168:171]
    v_mfma_f32_16x16x32_bf16 v[164:167], v[64:67], v[132:135], v[164:167]
    v_mfma_f32_16x16x32_bf16 v[164:167], v[68:71], v[132:135], v[164:167]
    s_waitcnt lgkmcnt(15)
    v_mfma_f32_16x16x32_bf16 v[168:171], v[80:83], v[128:131], v[168:171]
    v_mfma_f32_16x16x32_bf16 v[168:171], v[84:87], v[128:131], v[168:171]
    v_mfma_f32_16x16x32_bf16 v[172:175], v[80:83], v[132:135], v[172:175]
    v_mfma_f32_16x16x32_bf16 v[172:175], v[84:87], v[132:135], v[172:175]
    v_mfma_f32_16x16x32_bf16 v[176:179], v[80:83], v[136:139], v[176:179]
    v_mfma_f32_16x16x32_bf16 v[176:179], v[84:87], v[136:139], v[176:179]
    v_mfma_f32_16x16x32_bf16 v[168:171], v[64:67], v[136:139], v[168:171]
    v_mfma_f32_16x16x32_bf16 v[168:171], v[68:71], v[136:139], v[168:171]
    v_mfma_f32_16x16x32_bf16 v[172:175], v[72:75], v[136:139], v[172:175]
    v_mfma_f32_16x16x32_bf16 v[172:175], v[76:79], v[136:139], v[172:175]
    s_waitcnt lgkmcnt(15)
    v_mfma_f32_16x16x32_bf16 v[172:175], v[88:91], v[128:131], v[172:175]
    v_mfma_f32_16x16x32_bf16 v[172:175], v[92:95], v[128:131], v[172:175]
    v_mfma_f32_16x16x32_bf16 v[176:179], v[88:91], v[132:135], v[176:179]
    v_mfma_f32_16x16x32_bf16 v[176:179], v[92:95], v[132:135], v[176:179]
    v_mfma_f32_16x16x32_bf16 v[180:183], v[88:91], v[136:139], v[180:183]
    v_mfma_f32_16x16x32_bf16 v[180:183], v[92:95], v[136:139], v[180:183]
    v_mfma_f32_16x16x32_bf16 v[184:187], v[88:91], v[140:143], v[184:187]
    v_mfma_f32_16x16x32_bf16 v[184:187], v[92:95], v[140:143], v[184:187]
    v_mfma_f32_16x16x32_bf16 v[172:175], v[64:67], v[140:143], v[172:175]
    v_mfma_f32_16x16x32_bf16 v[172:175], v[68:71], v[140:143], v[172:175]
    v_mfma_f32_16x16x32_bf16 v[176:179], v[72:75], v[140:143], v[176:179]
    v_mfma_f32_16x16x32_bf16 v[176:179], v[76:79], v[140:143], v[176:179]
    v_mfma_f32_16x16x32_bf16 v[180:183], v[80:83], v[140:143], v[180:183]
    v_mfma_f32_16x16x32_bf16 v[180:183], v[84:87], v[140:143], v[180:183]
    s_waitcnt lgkmcnt(12)
    v_mfma_f32_16x16x32_bf16 v[176:179], v[96:99], v[128:131], v[176:179]
    v_mfma_f32_16x16x32_bf16 v[176:179], v[100:103], v[128:131], v[176:179]
    v_mfma_f32_16x16x32_bf16 v[180:183], v[96:99], v[132:135], v[180:183]
    v_mfma_f32_16x16x32_bf16 v[180:183], v[100:103], v[132:135], v[180:183]
    v_mfma_f32_16x16x32_bf16 v[184:187], v[96:99], v[136:139], v[184:187]
    v_mfma_f32_16x16x32_bf16 v[184:187], v[100:103], v[136:139], v[184:187]
    v_mfma_f32_16x16x32_bf16 v[188:191], v[96:99], v[140:143], v[188:191]
    v_mfma_f32_16x16x32_bf16 v[188:191], v[100:103], v[140:143], v[188:191]
    v_mfma_f32_16x16x32_bf16 v[176:179], v[64:67], v[144:147], v[176:179]
    v_mfma_f32_16x16x32_bf16 v[176:179], v[68:71], v[144:147], v[176:179]
    v_mfma_f32_16x16x32_bf16 v[180:183], v[72:75], v[144:147], v[180:183]
    v_mfma_f32_16x16x32_bf16 v[180:183], v[76:79], v[144:147], v[180:183]
    v_mfma_f32_16x16x32_bf16 v[184:187], v[80:83], v[144:147], v[184:187]
    v_mfma_f32_16x16x32_bf16 v[184:187], v[84:87], v[144:147], v[184:187]
    v_mfma_f32_16x16x32_bf16 v[188:191], v[88:91], v[144:147], v[188:191]
    v_mfma_f32_16x16x32_bf16 v[188:191], v[92:95], v[144:147], v[188:191]
    s_waitcnt lgkmcnt(8)
    v_mfma_f32_16x16x32_bf16 v[180:183], v[104:107], v[128:131], v[180:183]
    v_mfma_f32_16x16x32_bf16 v[180:183], v[108:111], v[128:131], v[180:183]
    v_mfma_f32_16x16x32_bf16 v[184:187], v[104:107], v[132:135], v[184:187]
    v_mfma_f32_16x16x32_bf16 v[184:187], v[108:111], v[132:135], v[184:187]
    v_mfma_f32_16x16x32_bf16 v[188:191], v[104:107], v[136:139], v[188:191]
    v_mfma_f32_16x16x32_bf16 v[188:191], v[108:111], v[136:139], v[188:191]
    v_mfma_f32_16x16x32_bf16 v[180:183], v[64:67], v[148:151], v[180:183]
    v_mfma_f32_16x16x32_bf16 v[180:183], v[68:71], v[148:151], v[180:183]
    v_mfma_f32_16x16x32_bf16 v[184:187], v[72:75], v[148:151], v[184:187]
    v_mfma_f32_16x16x32_bf16 v[184:187], v[76:79], v[148:151], v[184:187]
    v_mfma_f32_16x16x32_bf16 v[188:191], v[80:83], v[148:151], v[188:191]
    v_mfma_f32_16x16x32_bf16 v[188:191], v[84:87], v[148:151], v[188:191]
    s_waitcnt lgkmcnt(4)
    v_mfma_f32_16x16x32_bf16 v[184:187], v[112:115], v[128:131], v[184:187]
    v_mfma_f32_16x16x32_bf16 v[184:187], v[116:119], v[128:131], v[184:187]
    v_mfma_f32_16x16x32_bf16 v[188:191], v[112:115], v[132:135], v[188:191]
    v_mfma_f32_16x16x32_bf16 v[188:191], v[116:119], v[132:135], v[188:191]
    v_mfma_f32_16x16x32_bf16 v[184:187], v[64:67], v[152:155], v[184:187]
    v_mfma_f32_16x16x32_bf16 v[184:187], v[68:71], v[152:155], v[184:187]
    v_mfma_f32_16x16x32_bf16 v[188:191], v[72:75], v[152:155], v[188:191]
    v_mfma_f32_16x16x32_bf16 v[188:191], v[76:79], v[152:155], v[188:191]
    s_waitcnt lgkmcnt(0)
    v_mfma_f32_16x16x32_bf16 v[188:191], v[120:123], v[128:131], v[188:191]
    v_mfma_f32_16x16x32_bf16 v[188:191], v[124:127], v[128:131], v[188:191]
    v_mfma_f32_16x16x32_bf16 v[188:191], v[64:67], v[156:159], v[188:191]
    v_mfma_f32_16x16x32_bf16 v[188:191], v[68:71], v[156:159], v[188:191]
    s_lshl_b32 s7, s6, 13
    s_add_u32 s7, s7, 53248
    v_lshlrev_b32 v9, 2, v2
    v_add_u32 v9, s7, v9
    ds_write_b32 v9, v160 offset:0
    ds_write_b32 v9, v161 offset:256
    ds_write_b32 v9, v162 offset:512
    ds_write_b32 v9, v163 offset:768
    ds_write_b32 v9, v164 offset:1024
    ds_write_b32 v9, v165 offset:1280
    ds_write_b32 v9, v166 offset:1536
    ds_write_b32 v9, v167 offset:1792
    ds_write_b32 v9, v168 offset:2048
    ds_write_b32 v9, v169 offset:2304
    ds_write_b32 v9, v170 offset:2560
    ds_write_b32 v9, v171 offset:2816
    ds_write_b32 v9, v172 offset:3072
    ds_write_b32 v9, v173 offset:3328
    ds_write_b32 v9, v174 offset:3584
    ds_write_b32 v9, v175 offset:3840
    ds_write_b32 v9, v176 offset:4096
    ds_write_b32 v9, v177 offset:4352
    ds_write_b32 v9, v178 offset:4608
    ds_write_b32 v9, v179 offset:4864
    ds_write_b32 v9, v180 offset:5120
    ds_write_b32 v9, v181 offset:5376
    ds_write_b32 v9, v182 offset:5632
    ds_write_b32 v9, v183 offset:5888
    ds_write_b32 v9, v184 offset:6144
    ds_write_b32 v9, v185 offset:6400
    ds_write_b32 v9, v186 offset:6656
    ds_write_b32 v9, v187 offset:6912
    ds_write_b32 v9, v188 offset:7168
    ds_write_b32 v9, v189 offset:7424
    ds_write_b32 v9, v190 offset:7680
    ds_write_b32 v9, v191 offset:7936
    v_lshrrev_b32 v9, 5, v3
    v_bfe_u32 v10, v3, 1, 4
    v_and_b32 v11, 3, v10
    v_lshl_add_u32 v9, v9, 2, v11
    v_lshlrev_b32 v9, 8, v9
    v_lshrrev_b32 v10, 2, v10
    v_lshl_add_u32 v9, v10, 6, v9
    v_and_b32 v11, 1, v3
    v_lshl_add_u32 v9, v11, 5, v9
    s_lshl_b32 s7, s8, 15
    s_add_u32 s7, s7, 53248
    v_add_u32 v9, s7, v9
    v_lshlrev_b32 v200, 16, v200
    v_lshlrev_b32 v25, 16, v192
    v_and_b32 v26, s24, v192
    v_mul_f32 v25, v25, v200
    v_mul_f32 v26, v26, v200
    v_cvt_pk_bf16_f32 v27, v25, v26
    v_lshlrev_b32 v208, 16, v27
    v_and_b32 v209, s24, v27
    v_lshlrev_b32 v216, 16, v196
    v_and_b32 v217, s24, v196
    v_lshlrev_b32 v25, 16, v193
    v_and_b32 v26, s24, v193
    v_mul_f32 v25, v25, v200
    v_mul_f32 v26, v26, v200
    v_cvt_pk_bf16_f32 v27, v25, v26
    v_lshlrev_b32 v210, 16, v27
    v_and_b32 v211, s24, v27
    v_lshlrev_b32 v218, 16, v197
    v_and_b32 v219, s24, v197
    v_lshlrev_b32 v25, 16, v194
    v_and_b32 v26, s24, v194
    v_mul_f32 v25, v25, v200
    v_mul_f32 v26, v26, v200
    v_cvt_pk_bf16_f32 v27, v25, v26
    v_lshlrev_b32 v212, 16, v27
    v_and_b32 v213, s24, v27
    v_lshlrev_b32 v220, 16, v198
    v_and_b32 v221, s24, v198
    v_lshlrev_b32 v25, 16, v195
    v_and_b32 v26, s24, v195
    v_mul_f32 v25, v25, v200
    v_mul_f32 v26, v26, v200
    v_cvt_pk_bf16_f32 v27, v25, v26
    v_lshlrev_b32 v214, 16, v27
    v_and_b32 v215, s24, v27
    v_lshlrev_b32 v222, 16, v199
    v_and_b32 v223, s24, v199
    s_waitcnt lgkmcnt(0)
    s_barrier
    ds_read_b128 v[64:67], v9 offset:0
    ds_read_b128 v[68:71], v9 offset:16
    ds_read_b128 v[72:75], v9 offset:8192
    ds_read_b128 v[76:79], v9 offset:8208
    ds_read_b128 v[80:83], v9 offset:16384
    ds_read_b128 v[84:87], v9 offset:16400
    ds_read_b128 v[88:91], v9 offset:24576
    ds_read_b128 v[92:95], v9 offset:24592
    s_waitcnt lgkmcnt(0)
    v_add_f32 v64, v64, v72
    v_add_f32 v80, v80, v88
    v_add_f32 v64, v64, v80
    v_add_f32 v65, v65, v73
    v_add_f32 v81, v81, v89
    v_add_f32 v65, v65, v81
    v_add_f32 v66, v66, v74
    v_add_f32 v82, v82, v90
    v_add_f32 v66, v66, v82
    v_add_f32 v67, v67, v75
    v_add_f32 v83, v83, v91
    v_add_f32 v67, v67, v83
    v_add_f32 v68, v68, v76
    v_add_f32 v84, v84, v92
    v_add_f32 v68, v68, v84
    v_add_f32 v69, v69, v77
    v_add_f32 v85, v85, v93
    v_add_f32 v69, v69, v85
    v_add_f32 v70, v70, v78
    v_add_f32 v86, v86, v94
    v_add_f32 v70, v70, v86
    v_add_f32 v71, v71, v79
    v_add_f32 v87, v87, v95
    v_add_f32 v71, v71, v87
    v_cvt_pk_bf16_f32 v24, v64, v65
    v_lshlrev_b32 v25, 16, v24
    v_and_b32 v26, s24, v24
    v_add_f32 v25, v25, v208
    v_add_f32 v26, v26, v209
    v_cvt_pk_bf16_f32 v24, v25, v26
    v_lshlrev_b32 v25, 16, v24
    v_and_b32 v26, s24, v24
    v_add_f32 v25, v25, v216
    v_add_f32 v26, v26, v217
    v_cvt_pk_bf16_f32 v32, v25, v26
    v_cvt_pk_bf16_f32 v24, v66, v67
    v_lshlrev_b32 v25, 16, v24
    v_and_b32 v26, s24, v24
    v_add_f32 v25, v25, v210
    v_add_f32 v26, v26, v211
    v_cvt_pk_bf16_f32 v24, v25, v26
    v_lshlrev_b32 v25, 16, v24
    v_and_b32 v26, s24, v24
    v_add_f32 v25, v25, v218
    v_add_f32 v26, v26, v219
    v_cvt_pk_bf16_f32 v33, v25, v26
    v_cvt_pk_bf16_f32 v24, v68, v69
    v_lshlrev_b32 v25, 16, v24
    v_and_b32 v26, s24, v24
    v_add_f32 v25, v25, v212
    v_add_f32 v26, v26, v213
    v_cvt_pk_bf16_f32 v24, v25, v26
    v_lshlrev_b32 v25, 16, v24
    v_and_b32 v26, s24, v24
    v_add_f32 v25, v25, v220
    v_add_f32 v26, v26, v221
    v_cvt_pk_bf16_f32 v34, v25, v26
    v_cvt_pk_bf16_f32 v24, v70, v71
    v_lshlrev_b32 v25, 16, v24
    v_and_b32 v26, s24, v24
    v_add_f32 v25, v25, v214
    v_add_f32 v26, v26, v215
    v_cvt_pk_bf16_f32 v24, v25, v26
    v_lshlrev_b32 v25, 16, v24
    v_and_b32 v26, s24, v24
    v_add_f32 v25, v25, v222
    v_add_f32 v26, v26, v223
    v_cvt_pk_bf16_f32 v35, v25, v26
    global_store_dwordx4 v4, v[32:35], s[30:31] sc1
    s_endpgm
K12_TR:
    v_mov_b32 v7, 0
    v_mov_b32 v15, 147968
    ds_write_b32 v15, v7
    ds_write_b32 v15, v7 offset:4
    s_mov_b32 s3, s2
    s_lshl_b32 s3, s3, 6
    v_lshrrev_b32 v3, 3, v0
    v_and_b32 v4, 7, v0
    v_add_u32 v5, s3, v3
    s_movk_i32 s7, 896
    v_mul_lo_u32 v6, v5, s7
    v_lshl_add_u32 v6, v4, 4, v6
    s_waitcnt lgkmcnt(0)
    s_or_b32 s7, s2, s6
    s_cmp_lg_u32 s7, 0
    s_cbranch_scc1 K12_NOTAG
    s_memrealtime s[68:69]
    s_waitcnt lgkmcnt(0)
    s_or_b32 s68, s68, 1
    v_mov_b32 v7, s68
    v_mov_b32 v15, 0
    global_store_dword v15, v7, s[62:63] sc1
    v_mov_b32 v15, 0x20000
    global_store_dword v15, v7, s[64:65] sc1
K12_NOTAG:
    s_barrier
    global_load_dwordx4 v[16:19], v6, s[36:37] offset:0
    global_load_dwordx4 v[20:23], v6, s[36:37] offset:128
    global_load_dwordx4 v[24:27], v6, s[36:37] offset:256
    global_load_dwordx4 v[28:31], v6, s[36:37] offset:384
    global_load_dwordx4 v[32:35], v6, s[36:37] offset:512
    global_load_dwordx4 v[36:39], v6, s[36:37] offset:640
    global_load_dwordx4 v[40:43], v6, s[36:37] offset:768
    s_waitcnt vmcnt(0)
    v_mov_b32 v207, 0
    global_load_dword v207, v207, s[62:63] sc1
K12_TRX:
    v_mov_b32 v44, s24
    v_lshlrev_b32 v48, 16, v16
    v_and_b32 v49, v44, v16
    v_lshlrev_b32 v50, 16, v17
    v_and_b32 v51, v44, v17
    v_lshlrev_b32 v52, 16, v18
    v_and_b32 v53, v44, v18
    v_lshlrev_b32 v54, 16, v19
    v_and_b32 v55, v44, v19
    v_lshlrev_b32 v56, 16, v20
    v_and_b32 v57, v44, v20
    v_lshlrev_b32 v58, 16, v21
    v_and_b32 v59, v44, v21
    v_lshlrev_b32 v60, 16, v22
    v_and_b32 v61, v44, v22
    v_lshlrev_b32 v62, 16, v23
    v_and_b32 v63, v44, v23
    v_lshlrev_b32 v64, 16, v24
    v_and_b32 v65, v44, v24
    v_lshlrev_b32 v66, 16, v25
    v_and_b32 v67, v44, v25
    v_lshlrev_b32 v68, 16, v26
    v_and_b32 v69, v44, v26
    v_lshlrev_b32 v70, 16, v27
    v_and_b32 v71, v44, v27
    v_lshlrev_b32 v72, 16, v28
    v_and_b32 v73, v44, v28
    v_lshlrev_b32 v74, 16, v29
    v_and_b32 v75, v44, v29
    v_lshlrev_b32 v76, 16, v30
    v_and_b32 v77, v44, v30
    v_lshlrev_b32 v78, 16, v31
    v_and_b32 v79, v44, v31
    v_lshlrev_b32 v80, 16, v32
    v_and_b32 v81, v44, v32
    v_lshlrev_b32 v82, 16, v33
    v_and_b32 v83, v44, v33
    v_lshlrev_b32 v84, 16, v34
    v_and_b32 v85, v44, v34
    v_lshlrev_b32 v86, 16, v35
    v_and_b32 v87, v44, v35
    v_lshlrev_b32 v88, 16, v36
    v_and_b32 v89, v44, v36
    v_lshlrev_b32 v90, 16, v37
    v_and_b32 v91, v44, v37
    v_lshlrev_b32 v92, 16, v38
    v_and_b32 v93, v44, v38
    v_lshlrev_b32 v94, 16, v39
    v_and_b32 v95, v44, v39
    v_lshlrev_b32 v96, 16, v40
    v_and_b32 v97, v44, v40
    v_lshlrev_b32 v98, 16, v41
    v_and_b32 v99, v44, v41
    v_lshlrev_b32 v100, 16, v42
    v_and_b32 v101, v44, v42
    v_lshlrev_b32 v102, 16, v43
    v_and_b32 v103, v44, v43
    v_add_f32 v8, v48, v49
    v_add_f32 v9, v50, v51
    v_add_f32 v8, v8, v52
    v_add_f32 v8, v8, v53
    v_add_f32 v9, v9, v54
    v_add_f32 v9, v9, v55
    v_add_f32 v8, v8, v56
    v_add_f32 v8, v8, v57
    v_add_f32 v9, v9, v58
    v_add_f32 v9, v9, v59
    v_add_f32 v8, v8, v60
    v_add_f32 v8, v8, v61
    v_add_f32 v9, v9, v62
    v_add_f32 v9, v9, v63
    v_add_f32 v8, v8, v64
    v_add_f32 v8, v8, v65
    v_add_f32 v9, v9, v66
    v_add_f32 v9, v9, v67
    v_add_f32 v8, v8, v68
    v_add_f32 v8, v8, v69
    v_add_f32 v9, v9, v70
    v_add_f32 v9, v9, v71
    v_add_f32 v8, v8, v72
    v_add_f32 v8, v8, v73
    v_add_f32 v9, v9, v74
    v_add_f32 v9, v9, v75
    v_add_f32 v8, v8, v76
    v_add_f32 v8, v8, v77
    v_add_f32 v9, v9, v78
    v_add_f32 v9, v9, v79
    v_add_f32 v8, v8, v80
    v_add_f32 v8, v8, v81
    v_add_f32 v9, v9, v82
    v_add_f32 v9, v9, v83
    v_add_f32 v8, v8, v84
    v_add_f32 v8, v8, v85
    v_add_f32 v9, v9, v86
    v_add_f32 v9, v9, v87
    v_add_f32 v8, v8, v88
    v_add_f32 v8, v8, v89
    v_add_f32 v9, v9, v90
    v_add_f32 v9, v9, v91
    v_add_f32 v8, v8, v92
    v_add_f32 v8, v8, v93
    v_add_f32 v9, v9, v94
    v_add_f32 v9, v9, v95
    v_add_f32 v8, v8, v96
    v_add_f32 v8, v8, v97
    v_add_f32 v9, v9, v98
    v_add_f32 v9, v9, v99
    v_add_f32 v8, v8, v100
    v_add_f32 v8, v8, v101
    v_add_f32 v9, v9, v102
    v_add_f32 v9, v9, v103
    v_add_f32 v8, v8, v9
    s_nop 1
    v_add_f32_dpp v8, v8, v8 quad_perm:[1,0,3,2] row_mask:0xf bank_mask:0xf
    s_nop 1
    v_add_f32_dpp v8, v8, v8 quad_perm:[2,3,0,1] row_mask:0xf bank_mask:0xf
    s_nop 1
    v_add_f32_dpp v8, v8, v8 row_half_mirror row_mask:0xf bank_mask:0xf
    s_mov_b32 s8, 0x3b124925
    v_mul_f32 v8, s8, v8
    v_mov_b32 v10, 0
    v_mov_b32 v11, 0
    v_sub_f32 v12, v48, v8
    v_fma_f32 v10, v12, v12, v10
    v_sub_f32 v13, v49, v8
    v_fma_f32 v11, v13, v13, v11
    v_sub_f32 v12, v50, v8
    v_fma_f32 v10, v12, v12, v10
    v_sub_f32 v13, v51, v8
    v_fma_f32 v11, v13, v13, v11
    v_sub_f32 v12, v52, v8
    v_fma_f32 v10, v12, v12, v10
    v_sub_f32 v13, v53, v8
    v_fma_f32 v11, v13, v13, v11
    v_sub_f32 v12, v54, v8
    v_fma_f32 v10, v12, v12, v10
    v_sub_f32 v13, v55, v8
    v_fma_f32 v11, v13, v13, v11
    v_sub_f32 v12, v56, v8
    v_fma_f32 v10, v12, v12, v10
    v_sub_f32 v13, v57, v8
    v_fma_f32 v11, v13, v13, v11
    v_sub_f32 v12, v58, v8
    v_fma_f32 v10, v12, v12, v10
    v_sub_f32 v13, v59, v8
    v_fma_f32 v11, v13, v13, v11
    v_sub_f32 v12, v60, v8
    v_fma_f32 v10, v12, v12, v10
    v_sub_f32 v13, v61, v8
    v_fma_f32 v11, v13, v13, v11
    v_sub_f32 v12, v62, v8
    v_fma_f32 v10, v12, v12, v10
    v_sub_f32 v13, v63, v8
    v_fma_f32 v11, v13, v13, v11
    v_sub_f32 v12, v64, v8
    v_fma_f32 v10, v12, v12, v10
    v_sub_f32 v13, v65, v8
    v_fma_f32 v11, v13, v13, v11
    v_sub_f32 v12, v66, v8
    v_fma_f32 v10, v12, v12, v10
    v_sub_f32 v13, v67, v8
    v_fma_f32 v11, v13, v13, v11
    v_sub_f32 v12, v68, v8
    v_fma_f32 v10, v12, v12, v10
    v_sub_f32 v13, v69, v8
    v_fma_f32 v11, v13, v13, v11
    v_sub_f32 v12, v70, v8
    v_fma_f32 v10, v12, v12, v10
    v_sub_f32 v13, v71, v8
    v_fma_f32 v11, v13, v13, v11
    v_sub_f32 v12, v72, v8
    v_fma_f32 v10, v12, v12, v10
    v_sub_f32 v13, v73, v8
    v_fma_f32 v11, v13, v13, v11
    v_sub_f32 v12, v74, v8
    v_fma_f32 v10, v12, v12, v10
    v_sub_f32 v13, v75, v8
    v_fma_f32 v11, v13, v13, v11
    v_sub_f32 v12, v76, v8
    v_fma_f32 v10, v12, v12, v10
    v_sub_f32 v13, v77, v8
    v_fma_f32 v11, v13, v13, v11
    v_sub_f32 v12, v78, v8
    v_fma_f32 v10, v12, v12, v10
    v_sub_f32 v13, v79, v8
    v_fma_f32 v11, v13, v13, v11
    v_sub_f32 v12, v80, v8
    v_fma_f32 v10, v12, v12, v10
    v_sub_f32 v13, v81, v8
    v_fma_f32 v11, v13, v13, v11
    v_sub_f32 v12, v82, v8
    v_fma_f32 v10, v12, v12, v10
    v_sub_f32 v13, v83, v8
    v_fma_f32 v11, v13, v13, v11
    v_sub_f32 v12, v84, v8
    v_fma_f32 v10, v12, v12, v10
    v_sub_f32 v13, v85, v8
    v_fma_f32 v11, v13, v13, v11
    v_sub_f32 v12, v86, v8
    v_fma_f32 v10, v12, v12, v10
    v_sub_f32 v13, v87, v8
    v_fma_f32 v11, v13, v13, v11
    v_sub_f32 v12, v88, v8
    v_fma_f32 v10, v12, v12, v10
    v_sub_f32 v13, v89, v8
    v_fma_f32 v11, v13, v13, v11
    v_sub_f32 v12, v90, v8
    v_fma_f32 v10, v12, v12, v10
    v_sub_f32 v13, v91, v8
    v_fma_f32 v11, v13, v13, v11
    v_sub_f32 v12, v92, v8
    v_fma_f32 v10, v12, v12, v10
    v_sub_f32 v13, v93, v8
    v_fma_f32 v11, v13, v13, v11
    v_sub_f32 v12, v94, v8
    v_fma_f32 v10, v12, v12, v10
    v_sub_f32 v13, v95, v8
    v_fma_f32 v11, v13, v13, v11
    v_sub_f32 v12, v96, v8
    v_fma_f32 v10, v12, v12, v10
    v_sub_f32 v13, v97, v8
    v_fma_f32 v11, v13, v13, v11
    v_sub_f32 v12, v98, v8
    v_fma_f32 v10, v12, v12, v10
    v_sub_f32 v13, v99, v8
    v_fma_f32 v11, v13, v13, v11
    v_sub_f32 v12, v100, v8
    v_fma_f32 v10, v12, v12, v10
    v_sub_f32 v13, v101, v8
    v_fma_f32 v11, v13, v13, v11
    v_sub_f32 v12, v102, v8
    v_fma_f32 v10, v12, v12, v10
    v_sub_f32 v13, v103, v8
    v_fma_f32 v11, v13, v13, v11
    v_add_f32 v10, v10, v11
    s_nop 1
    v_add_f32_dpp v10, v10, v10 quad_perm:[1,0,3,2] row_mask:0xf bank_mask:0xf
    s_nop 1
    v_add_f32_dpp v10, v10, v10 quad_perm:[2,3,0,1] row_mask:0xf bank_mask:0xf
    s_nop 1
    v_add_f32_dpp v10, v10, v10 row_half_mirror row_mask:0xf bank_mask:0xf
    v_mul_f32 v10, s8, v10
    v_cvt_pk_bf16_f32 v11, v8, v10
    v_lshlrev_b32 v8, 16, v11
    v_and_b32 v10, s24, v11
    v_add_f32 v10, 0x3727c5ac, v10
    v_cvt_pk_bf16_f32 v10, v10, v10
    v_lshlrev_b32 v10, 16, v10
    v_sqrt_f32 v10, v10
    s_nop 0
    v_cvt_pk_bf16_f32 v10, v10, v10
    v_lshlrev_b32 v10, 16, v10
    v_rcp_f32 v9, v10
    v_lshlrev_b32 v5, 3, v5
    v_cmp_eq_u32 vcc, 0, v4
    s_nop 0
    s_and_saveexec_b64 s[28:29], vcc
    global_store_dwordx2 v5, v[8:9], s[64:65] sc1
    s_mov_b64 exec, s[28:29]
    s_waitcnt vmcnt(0)
    v_readfirstlane_b32 s68, v207
    s_nop 0
    s_cmp_lg_u32 s68, 0
    s_cbranch_scc1 K12_T2_OK
    s_mov_b32 s69, 0
K12_T2_L:
    s_sleep 4
    v_mov_b32 v207, 0
    global_load_dword v207, v207, s[62:63] sc1
    s_waitcnt vmcnt(0)
    v_readfirstlane_b32 s68, v207
    s_add_u32 s69, s69, 1
    s_cmp_lg_u32 s68, 0
    s_cbranch_scc1 K12_T2_OK
    s_cmp_lt_u32 s69, 20000
    s_cbranch_scc1 K12_T2_L
K12_T2_OK:
    v_mov_b32 v7, 1
    v_mov_b32 v15, 147968
    s_mov_b64 exec, 1
    ds_add_rtn_u32 v7, v15, v7
    s_waitcnt lgkmcnt(0)
    v_readfirstlane_b32 s7, v7
    s_nop 0
    s_cmp_lg_u32 s7, 7
    s_cbranch_scc1 K12_NOSIG
    v_mov_b32 v7, s68
    s_add_u32 s7, s2, 224
    s_lshl_b32 s7, s7, 7
    s_add_u32 s7, s7, 0x10000
    v_mov_b32 v15, s7
    global_store_dword v15, v7, s[64:65] sc1
K12_NOSIG:
    s_mov_b64 exec, -1
    s_barrier
    s_lshl_b32 s3, s2, 3
    s_add_u32 s3, s3, s6
    s_mul_i32 s7, s6, 5120
    v_lshrrev_b32 v3, 3, v2
    v_and_b32 v4, 7, v2
    s_movk_i32 s8, 3584
    v_mul_lo_u32 v5, v3, s8
    v_lshl_add_u32 v5, v4, 4, v5
    s_movk_i32 s8, 896
    v_mul_lo_u32 v11, v3, s8
    v_lshl_add_u32 v11, v4, 4, v11
    s_movk_i32 s8, 160
    v_mul_lo_u32 v6, v3, s8
    v_lshl_add_u32 v6, v4, 4, v6
    v_add_u32 v6, s7, v6
    v_lshrrev_b32 v7, 4, v2
    v_bfe_u32 v8, v2, 2, 2
    v_lshl_add_u32 v12, v7, 3, v8
    v_lshl_add_u32 v7, v7, 2, v8
    v_mul_lo_u32 v7, v7, s8
    v_mul_lo_u32 v12, v12, s8
    v_and_b32 v8, 3, v2
    v_lshl_add_u32 v7, v8, 4, v7
    v_add_u32 v7, s7, v7
    v_lshl_add_u32 v12, v8, 3, v12
    v_add_u32 v12, s7, v12
    v_lshlrev_b32 v8, 4, v2
    s_add_u32 s34, s64, 0xa00000
    s_addc_u32 s35, s65, 0
    s_add_u32 s28, s64, 0xc00000
    s_addc_u32 s29, s65, 0
    s_add_u32 s4, s3, 256
    s_min_u32 s4, s4, 391
    s_mul_i32 s40, s3, 9363
    s_lshr_b32 s40, s40, 18
    s_mul_i32 s41, s40, 28
    s_sub_u32 s41, s3, s41
    s_mul_i32 s42, s3, 9363
    s_lshr_b32 s42, s42, 16
    s_mul_i32 s43, s42, 7
    s_sub_u32 s43, s3, s43
    s_mul_i32 s44, s4, 9363
    s_lshr_b32 s44, s44, 18
    s_mul_i32 s45, s44, 28
    s_sub_u32 s45, s4, s45
    s_mul_i32 s46, s4, 9363
    s_lshr_b32 s46, s46, 16
    s_mul_i32 s47, s46, 7
    s_sub_u32 s47, s4, s47
    s_mul_i32 s11, s40, 114688
    s_lshl_b32 s12, s41, 7
    s_add_u32 s11, s11, s12
    v_add_u32 v9, s11, v5
    global_load_dwordx4 v[64:67], v9, s[56:57]
    v_add_u32 v9, 28672, v9
    global_load_dwordx4 v[68:71], v9, s[56:57]
    v_add_u32 v9, 28672, v9
    global_load_dwordx4 v[72:75], v9, s[56:57]
    v_add_u32 v9, 28672, v9
    global_load_dwordx4 v[76:79], v9, s[56:57]
    s_mul_i32 s11, s44, 114688
    s_lshl_b32 s12, s45, 7
    s_add_u32 s11, s11, s12
    v_add_u32 v9, s11, v5
    global_load_dwordx4 v[80:83], v9, s[56:57]
    v_add_u32 v9, 28672, v9
    global_load_dwordx4 v[84:87], v9, s[56:57]
    v_add_u32 v9, 28672, v9
    global_load_dwordx4 v[88:91], v9, s[56:57]
    v_add_u32 v9, 28672, v9
    global_load_dwordx4 v[92:95], v9, s[56:57]
    s_mul_i32 s11, s42, 28672
    s_lshl_b32 s12, s43, 7
    s_add_u32 s11, s11, s12
    v_add_u32 v9, s11, v11
    global_load_dwordx4 v[96:99], v9, s[58:59]
    v_add_u32 v9, 7168, v9
    global_load_dwordx4 v[100:103], v9, s[58:59]
    v_add_u32 v9, 7168, v9
    global_load_dwordx4 v[104:107], v9, s[58:59]
    v_add_u32 v9, 7168, v9
    global_load_dwordx4 v[108:111], v9, s[58:59]
    s_mul_i32 s11, s46, 28672
    s_lshl_b32 s12, s47, 7
    s_add_u32 s11, s11, s12
    v_add_u32 v9, s11, v11
    global_load_dwordx4 v[112:115], v9, s[58:59]
    v_add_u32 v9, 7168, v9
    global_load_dwordx4 v[116:119], v9, s[58:59]
    v_add_u32 v9, 7168, v9
    global_load_dwordx4 v[120:123], v9, s[58:59]
    v_add_u32 v9, 7168, v9
    global_load_dwordx4 v[124:127], v9, s[58:59]
    s_waitcnt vmcnt(12)
    ds_write_b128 v6, v[64:67] offset:0
    ds_write_b128 v6, v[68:71] offset:1280
    ds_write_b128 v6, v[72:75] offset:2560
    ds_write_b128 v6, v[76:79] offset:3840
    s_waitcnt lgkmcnt(0)
    ds_read_b64_tr_b16 v[128:129], v7 offset:0
    ds_read_b64_tr_b16 v[130:131], v7 offset:2560
    ds_read_b64_tr_b16 v[132:133], v7 offset:8
    ds_read_b64_tr_b16 v[134:135], v7 offset:2568
    ds_read_b64_tr_b16 v[136:137], v7 offset:64
    ds_read_b64_tr_b16 v[138:139], v7 offset:2624
    ds_read_b64_tr_b16 v[140:141], v7 offset:72
    ds_read_b64_tr_b16 v[142:143], v7 offset:2632
    s_mul_i32 s11, s41, 57344
    s_lshl_b32 s12, s40, 11
    s_add_u32 s11, s11, s12
    v_add_u32 v9, s11, v8
    v_add_u32 v10, 28672, v9
    s_waitcnt lgkmcnt(0)
    global_store_dwordx4 v9, v[128:131], s[34:35] sc1
    global_store_dwordx4 v9, v[132:135], s[34:35] offset:1024 sc1
    global_store_dwordx4 v10, v[136:139], s[34:35] sc1
    global_store_dwordx4 v10, v[140:143], s[34:35] offset:1024 sc1
    s_waitcnt vmcnt(12)
    ds_write_b128 v6, v[80:83] offset:0
    ds_write_b128 v6, v[84:87] offset:1280
    ds_write_b128 v6, v[88:91] offset:2560
    ds_write_b128 v6, v[92:95] offset:3840
    s_waitcnt lgkmcnt(0)
    ds_read_b64_tr_b16 v[144:145], v7 offset:0
    ds_read_b64_tr_b16 v[146:147], v7 offset:2560
    ds_read_b64_tr_b16 v[148:149], v7 offset:8
    ds_read_b64_tr_b16 v[150:151], v7 offset:2568
    ds_read_b64_tr_b16 v[152:153], v7 offset:64
    ds_read_b64_tr_b16 v[154:155], v7 offset:2624
    ds_read_b64_tr_b16 v[156:157], v7 offset:72
    ds_read_b64_tr_b16 v[158:159], v7 offset:2632
    s_mul_i32 s11, s45, 57344
    s_lshl_b32 s12, s44, 11
    s_add_u32 s11, s11, s12
    v_add_u32 v9, s11, v8
    v_add_u32 v10, 28672, v9
    s_waitcnt lgkmcnt(0)
    global_store_dwordx4 v9, v[144:147], s[34:35] sc1
    global_store_dwordx4 v9, v[148:151], s[34:35] offset:1024 sc1
    global_store_dwordx4 v10, v[152:155], s[34:35] sc1
    global_store_dwordx4 v10, v[156:159], s[34:35] offset:1024 sc1
    s_waitcnt vmcnt(12)
    ds_write_b128 v6, v[96:99] offset:0
    ds_write_b128 v6, v[100:103] offset:1280
    ds_write_b128 v6, v[104:107] offset:2560
    ds_write_b128 v6, v[108:111] offset:3840
    s_waitcnt lgkmcnt(0)
    ds_read_b64_tr_b16 v[160:161], v12 offset:0
    ds_read_b64_tr_b16 v[162:163], v12 offset:640
    ds_read_b64_tr_b16 v[164:165], v12 offset:32
    ds_read_b64_tr_b16 v[166:167], v12 offset:672
    ds_read_b64_tr_b16 v[168:169], v12 offset:64
    ds_read_b64_tr_b16 v[170:171], v12 offset:704
    ds_read_b64_tr_b16 v[172:173], v12 offset:96
    ds_read_b64_tr_b16 v[174:175], v12 offset:736
    s_mul_i32 s11, s43, 229376
    s_lshl_b32 s12, s42, 12
    s_add_u32 s11, s11, s12
    v_add_u32 v9, s11, v8
    s_waitcnt lgkmcnt(0)
    global_store_dwordx4 v9, v[160:163], s[28:29] offset:0 sc1
    global_store_dwordx4 v9, v[164:167], s[28:29] offset:1024 sc1
    global_store_dwordx4 v9, v[168:171], s[28:29] offset:2048 sc1
    global_store_dwordx4 v9, v[172:175], s[28:29] offset:3072 sc1
    s_waitcnt vmcnt(12)
    ds_write_b128 v6, v[112:115] offset:0
    ds_write_b128 v6, v[116:119] offset:1280
    ds_write_b128 v6, v[120:123] offset:2560
    ds_write_b128 v6, v[124:127] offset:3840
    s_waitcnt lgkmcnt(0)
    ds_read_b64_tr_b16 v[176:177], v12 offset:0
    ds_read_b64_tr_b16 v[178:179], v12 offset:640
    ds_read_b64_tr_b16 v[180:181], v12 offset:32
    ds_read_b64_tr_b16 v[182:183], v12 offset:672
    ds_read_b64_tr_b16 v[184:185], v12 offset:64
    ds_read_b64_tr_b16 v[186:187], v12 offset:704
    ds_read_b64_tr_b16 v[188:189], v12 offset:96
    ds_read_b64_tr_b16 v[190:191], v12 offset:736
    s_mul_i32 s11, s47, 229376
    s_lshl_b32 s12, s46, 12
    s_add_u32 s11, s11, s12
    v_add_u32 v9, s11, v8
    s_waitcnt lgkmcnt(0)
    global_store_dwordx4 v9, v[176:179], s[28:29] offset:0 sc1
    global_store_dwordx4 v9, v[180:183], s[28:29] offset:1024 sc1
    global_store_dwordx4 v9, v[184:187], s[28:29] offset:2048 sc1
    global_store_dwordx4 v9, v[188:191], s[28:29] offset:3072 sc1
K12_END:
    s_endpgm
.globl k34_kernel
.p2align 8
.type k34_kernel,@function
k34_kernel:
    s_cmp_ge_u32 s2, 256
    s_cbranch_scc1 K34_END
    s_load_dwordx2 s[32:33], s[0:1], 112
    s_cmp_ge_u32 s2, 224
    s_cbranch_scc1 K34_PF
    s_load_dwordx2 s[30:31], s[0:1], 96
    v_lshrrev_b32 v1, 6, v0
    s_nop 0
    v_readfirstlane_b32 s6, v1
    v_and_b32 v2, 63, v0
    s_and_b32 s3, s2, 7
    s_lshl_b32 s3, s3, 2
    s_bfe_u32 s4, s2, 0x20003
    s_add_u32 s3, s3, s4
    s_lshr_b32 s4, s2, 5
    s_lshl_b32 s5, s3, 7
    v_and_b32 v3, 7, v0
    v_lshrrev_b32 v4, 3, v0
    v_lshlrev_b32 v5, 4, v3
    v_add_u32 v5, s5, v5
    v_lshl_add_u32 v6, v4, 12, v5
    v_lshlrev_b32 v7, 1, v0
    v_add_u32 v7, s5, v7
    v_mov_b32 v8, 0
    v_mov_b32 v9, 139264
    ds_write_b32 v9, v8
    ds_write_b32 v9, v8 offset:4
    s_waitcnt lgkmcnt(0)
    s_add_u32 s12, s32, 0x800000
    s_addc_u32 s13, s33, 0
    s_mov_b32 s14, 0x1c0000
    s_mov_b32 s15, 0x00020000
    s_add_u32 s16, s32, 0xa00000
    s_addc_u32 s17, s33, 0
    s_mov_b32 s18, 0x188000
    s_mov_b32 s19, 0x00020000
    s_load_dword s60, s[32:33], 0x20000
    s_mov_b32 s20, 0x0
    s_mov_b32 s21, 0x40000
    s_mov_b32 s22, 0x80000
    s_mov_b32 s23, 0xc0000
    s_mov_b32 s24, 0x100000
    s_mov_b32 s25, 0x140000
    s_mov_b32 s26, 0x180000
    buffer_load_dwordx4 v[16:19], v6, s[12:15], s20 offen
    buffer_load_dwordx4 v[20:23], v6, s[12:15], s21 offen
    buffer_load_dwordx4 v[24:27], v6, s[12:15], s22 offen
    buffer_load_dwordx4 v[28:31], v6, s[12:15], s23 offen
    buffer_load_dwordx4 v[32:35], v6, s[12:15], s24 offen
    buffer_load_dwordx4 v[36:39], v6, s[12:15], s25 offen
    buffer_load_dwordx4 v[40:43], v6, s[12:15], s26 offen
    buffer_load_dwordx4 v[44:47], v5, s[12:15], 0 offen
    buffer_load_ushort v8, v7, s[12:15], 0 offen
    s_lshl_b32 s7, s4, 3
    s_add_u32 s7, s7, s6
    s_mul_i32 s8, s7, 28672
    v_lshlrev_b32 v9, 4, v2
    v_add_u32 v10, s8, v9
    s_mov_b32 s34, 0
    s_mov_b32 s35, 4096
    s_mov_b32 s36, 8192
    s_mov_b32 s37, 12288
    s_mov_b32 s38, 16384
    s_mov_b32 s39, 20480
    s_mov_b32 s40, 24576
    s_mov_b32 s41, 28672
    s_mov_b32 s44, 0xffff0000
    v_mov_b32 v248, s44
    s_waitcnt vmcnt(1)
    v_lshlrev_b32 v104, 16, v44
    v_and_b32 v105, s44, v44
    v_lshlrev_b32 v106, 16, v45
    v_and_b32 v107, s44, v45
    v_lshlrev_b32 v108, 16, v46
    v_and_b32 v109, s44, v46
    v_lshlrev_b32 v110, 16, v47
    v_and_b32 v111, s44, v47
    v_mov_b32 v112, 0
    v_mov_b32 v113, 0
    v_mov_b32 v114, 0
    v_mov_b32 v115, 0
    v_mov_b32 v116, 0
    v_mov_b32 v117, 0
    v_mov_b32 v118, 0
    v_mov_b32 v119, 0
    v_mov_b32 v120, 0
    v_mov_b32 v121, 0
    v_mov_b32 v122, 0
    v_mov_b32 v123, 0
    v_mov_b32 v124, 0
    v_mov_b32 v125, 0
    v_mov_b32 v126, 0
    v_mov_b32 v127, 0
    v_lshlrev_b32 v48, 16, v16
    v_and_b32 v49, v248, v16
    v_lshlrev_b32 v50, 16, v17
    v_and_b32 v51, v248, v17
    v_lshlrev_b32 v52, 16, v18
    v_and_b32 v53, v248, v18
    v_lshlrev_b32 v54, 16, v19
    v_and_b32 v55, v248, v19
    v_sub_f32 v12, v48, v104
    v_add_f32 v112, v112, v12
    v_fma_f32 v120, v12, v12, v120
    v_sub_f32 v13, v49, v105
    v_add_f32 v113, v113, v13
    v_fma_f32 v121, v13, v13, v121
    v_sub_f32 v14, v50, v106
    v_add_f32 v114, v114, v14
    v_fma_f32 v122, v14, v14, v122
    v_sub_f32 v15, v51, v107
    v_add_f32 v115, v115, v15
    v_fma_f32 v123, v15, v15, v123
    v_sub_f32 v12, v52, v108
    v_add_f32 v116, v116, v12
    v_fma_f32 v124, v12, v12, v124
    v_sub_f32 v13, v53, v109
    v_add_f32 v117, v117, v13
    v_fma_f32 v125, v13, v13, v125
    v_sub_f32 v14, v54, v110
    v_add_f32 v118, v118, v14
    v_fma_f32 v126, v14, v14, v126
    v_sub_f32 v15, v55, v111
    v_add_f32 v119, v119, v15
    v_fma_f32 v127, v15, v15, v127
    buffer_load_dwordx4 v[128:131], v10, s[16:19], s34 offen offset:0
    buffer_load_dwordx4 v[132:135], v10, s[16:19], s34 offen offset:1024
    v_lshlrev_b32 v56, 16, v20
    v_and_b32 v57, v248, v20
    v_lshlrev_b32 v58, 16, v21
    v_and_b32 v59, v248, v21
    v_lshlrev_b32 v60, 16, v22
    v_and_b32 v61, v248, v22
    v_lshlrev_b32 v62, 16, v23
    v_and_b32 v63, v248, v23
    v_sub_f32 v12, v56, v104
    v_add_f32 v112, v112, v12
    v_fma_f32 v120, v12, v12, v120
    v_sub_f32 v13, v57, v105
    v_add_f32 v113, v113, v13
    v_fma_f32 v121, v13, v13, v121
    v_sub_f32 v14, v58, v106
    v_add_f32 v114, v114, v14
    v_fma_f32 v122, v14, v14, v122
    v_sub_f32 v15, v59, v107
    v_add_f32 v115, v115, v15
    v_fma_f32 v123, v15, v15, v123
    v_sub_f32 v12, v60, v108
    v_add_f32 v116, v116, v12
    v_fma_f32 v124, v12, v12, v124
    v_sub_f32 v13, v61, v109
    v_add_f32 v117, v117, v13
    v_fma_f32 v125, v13, v13, v125
    v_sub_f32 v14, v62, v110
    v_add_f32 v118, v118, v14
    v_fma_f32 v126, v14, v14, v126
    v_sub_f32 v15, v63, v111
    v_add_f32 v119, v119, v15
    v_fma_f32 v127, v15, v15, v127
    buffer_load_dwordx4 v[136:139], v10, s[16:19], s34 offen offset:2048
    buffer_load_dwordx4 v[140:143], v10, s[16:19], s34 offen offset:3072
    v_lshlrev_b32 v64, 16, v24
    v_and_b32 v65, v248, v24
    v_lshlrev_b32 v66, 16, v25
    v_and_b32 v67, v248, v25
    v_lshlrev_b32 v68, 16, v26
    v_and_b32 v69, v248, v26
    v_lshlrev_b32 v70, 16, v27
    v_and_b32 v71, v248, v27
    v_sub_f32 v12, v64, v104
    v_add_f32 v112, v112, v12
    v_fma_f32 v120, v12, v12, v120
    v_sub_f32 v13, v65, v105
    v_add_f32 v113, v113, v13
    v_fma_f32 v121, v13, v13, v121
    v_sub_f32 v14, v66, v106
    v_add_f32 v114, v114, v14
    v_fma_f32 v122, v14, v14, v122
    v_sub_f32 v15, v67, v107
    v_add_f32 v115, v115, v15
    v_fma_f32 v123, v15, v15, v123
    v_sub_f32 v12, v68, v108
    v_add_f32 v116, v116, v12
    v_fma_f32 v124, v12, v12, v124
    v_sub_f32 v13, v69, v109
    v_add_f32 v117, v117, v13
    v_fma_f32 v125, v13, v13, v125
    v_sub_f32 v14, v70, v110
    v_add_f32 v118, v118, v14
    v_fma_f32 v126, v14, v14, v126
    v_sub_f32 v15, v71, v111
    v_add_f32 v119, v119, v15
    v_fma_f32 v127, v15, v15, v127
    buffer_load_dwordx4 v[144:147], v10, s[16:19], s35 offen offset:0
    buffer_load_dwordx4 v[148:151], v10, s[16:19], s35 offen offset:1024
    v_lshlrev_b32 v72, 16, v28
    v_and_b32 v73, v248, v28
    v_lshlrev_b32 v74, 16, v29
    v_and_b32 v75, v248, v29
    v_lshlrev_b32 v76, 16, v30
    v_and_b32 v77, v248, v30
    v_lshlrev_b32 v78, 16, v31
    v_and_b32 v79, v248, v31
    v_sub_f32 v12, v72, v104
    v_add_f32 v112, v112, v12
    v_fma_f32 v120, v12, v12, v120
    v_sub_f32 v13, v73, v105
    v_add_f32 v113, v113, v13
    v_fma_f32 v121, v13, v13, v121
    v_sub_f32 v14, v74, v106
    v_add_f32 v114, v114, v14
    v_fma_f32 v122, v14, v14, v122
    v_sub_f32 v15, v75, v107
    v_add_f32 v115, v115, v15
    v_fma_f32 v123, v15, v15, v123
    v_sub_f32 v12, v76, v108
    v_add_f32 v116, v116, v12
    v_fma_f32 v124, v12, v12, v124
    v_sub_f32 v13, v77, v109
    v_add_f32 v117, v117, v13
    v_fma_f32 v125, v13, v13, v125
    v_sub_f32 v14, v78, v110
    v_add_f32 v118, v118, v14
    v_fma_f32 v126, v14, v14, v126
    v_sub_f32 v15, v79, v111
    v_add_f32 v119, v119, v15
    v_fma_f32 v127, v15, v15, v127
    buffer_load_dwordx4 v[152:155], v10, s[16:19], s35 offen offset:2048
    buffer_load_dwordx4 v[156:159], v10, s[16:19], s35 offen offset:3072
    v_lshlrev_b32 v80, 16, v32
    v_and_b32 v81, v248, v32
    v_lshlrev_b32 v82, 16, v33
    v_and_b32 v83, v248, v33
    v_lshlrev_b32 v84, 16, v34
    v_and_b32 v85, v248, v34
    v_lshlrev_b32 v86, 16, v35
    v_and_b32 v87, v248, v35
    v_sub_f32 v12, v80, v104
    v_add_f32 v112, v112, v12
    v_fma_f32 v120, v12, v12, v120
    v_sub_f32 v13, v81, v105
    v_add_f32 v113, v113, v13
    v_fma_f32 v121, v13, v13, v121
    v_sub_f32 v14, v82, v106
    v_add_f32 v114, v114, v14
    v_fma_f32 v122, v14, v14, v122
    v_sub_f32 v15, v83, v107
    v_add_f32 v115, v115, v15
    v_fma_f32 v123, v15, v15, v123
    v_sub_f32 v12, v84, v108
    v_add_f32 v116, v116, v12
    v_fma_f32 v124, v12, v12, v124
    v_sub_f32 v13, v85, v109
    v_add_f32 v117, v117, v13
    v_fma_f32 v125, v13, v13, v125
    v_sub_f32 v14, v86, v110
    v_add_f32 v118, v118, v14
    v_fma_f32 v126, v14, v14, v126
    v_sub_f32 v15, v87, v111
    v_add_f32 v119, v119, v15
    v_fma_f32 v127, v15, v15, v127
    buffer_load_dwordx4 v[160:163], v10, s[16:19], s36 offen offset:0
    buffer_load_dwordx4 v[164:167], v10, s[16:19], s36 offen offset:1024
    v_lshlrev_b32 v88, 16, v36
    v_and_b32 v89, v248, v36
    v_lshlrev_b32 v90, 16, v37
    v_and_b32 v91, v248, v37
    v_lshlrev_b32 v92, 16, v38
    v_and_b32 v93, v248, v38
    v_lshlrev_b32 v94, 16, v39
    v_and_b32 v95, v248, v39
    v_sub_f32 v12, v88, v104
    v_add_f32 v112, v112, v12
    v_fma_f32 v120, v12, v12, v120
    v_sub_f32 v13, v89, v105
    v_add_f32 v113, v113, v13
    v_fma_f32 v121, v13, v13, v121
    v_sub_f32 v14, v90, v106
    v_add_f32 v114, v114, v14
    v_fma_f32 v122, v14, v14, v122
    v_sub_f32 v15, v91, v107
    v_add_f32 v115, v115, v15
    v_fma_f32 v123, v15, v15, v123
    v_sub_f32 v12, v92, v108
    v_add_f32 v116, v116, v12
    v_fma_f32 v124, v12, v12, v124
    v_sub_f32 v13, v93, v109
    v_add_f32 v117, v117, v13
    v_fma_f32 v125, v13, v13, v125
    v_sub_f32 v14, v94, v110
    v_add_f32 v118, v118, v14
    v_fma_f32 v126, v14, v14, v126
    v_sub_f32 v15, v95, v111
    v_add_f32 v119, v119, v15
    v_fma_f32 v127, v15, v15, v127
    buffer_load_dwordx4 v[168:171], v10, s[16:19], s36 offen offset:2048
    buffer_load_dwordx4 v[172:175], v10, s[16:19], s36 offen offset:3072
    v_lshlrev_b32 v96, 16, v40
    v_and_b32 v97, v248, v40
    v_lshlrev_b32 v98, 16, v41
    v_and_b32 v99, v248, v41
    v_lshlrev_b32 v100, 16, v42
    v_and_b32 v101, v248, v42
    v_lshlrev_b32 v102, 16, v43
    v_and_b32 v103, v248, v43
    v_sub_f32 v12, v96, v104
    v_add_f32 v112, v112, v12
    v_fma_f32 v120, v12, v12, v120
    v_sub_f32 v13, v97, v105
    v_add_f32 v113, v113, v13
    v_fma_f32 v121, v13, v13, v121
    v_sub_f32 v14, v98, v106
    v_add_f32 v114, v114, v14
    v_fma_f32 v122, v14, v14, v122
    v_sub_f32 v15, v99, v107
    v_add_f32 v115, v115, v15
    v_fma_f32 v123, v15, v15, v123
    v_sub_f32 v12, v100, v108
    v_add_f32 v116, v116, v12
    v_fma_f32 v124, v12, v12, v124
    v_sub_f32 v13, v101, v109
    v_add_f32 v117, v117, v13
    v_fma_f32 v125, v13, v13, v125
    v_sub_f32 v14, v102, v110
    v_add_f32 v118, v118, v14
    v_fma_f32 v126, v14, v14, v126
    v_sub_f32 v15, v103, v111
    v_add_f32 v119, v119, v15
    v_fma_f32 v127, v15, v15, v127
    buffer_load_dwordx4 v[176:179], v10, s[16:19], s37 offen offset:0
    buffer_load_dwordx4 v[180:183], v10, s[16:19], s37 offen offset:1024
    v_permlane32_swap_b32 v112, v120
    v_permlane32_swap_b32 v113, v121
    v_permlane32_swap_b32 v114, v122
    v_permlane32_swap_b32 v115, v123
    v_permlane32_swap_b32 v116, v124
    v_permlane32_swap_b32 v117, v125
    v_permlane32_swap_b32 v118, v126
    v_permlane32_swap_b32 v119, v127
    v_add_f32 v112, v112, v120
    v_add_f32 v113, v113, v121
    v_add_f32 v114, v114, v122
    v_add_f32 v115, v115, v123
    v_add_f32 v116, v116, v124
    v_add_f32 v117, v117, v125
    v_add_f32 v118, v118, v126
    v_add_f32 v119, v119, v127
    v_permlane16_swap_b32 v112, v116
    v_permlane16_swap_b32 v113, v117
    v_permlane16_swap_b32 v114, v118
    v_permlane16_swap_b32 v115, v119
    v_add_f32 v112, v112, v116
    v_add_f32 v113, v113, v117
    v_add_f32 v114, v114, v118
    v_add_f32 v115, v115, v119
    v_add_f32_dpp v112, v112, v112 row_ror:8 row_mask:0xf bank_mask:0xf
    v_add_f32_dpp v113, v113, v113 row_ror:8 row_mask:0xf bank_mask:0xf
    v_add_f32_dpp v114, v114, v114 row_ror:8 row_mask:0xf bank_mask:0xf
    v_add_f32_dpp v115, v115, v115 row_ror:8 row_mask:0xf bank_mask:0xf
    v_lshrrev_b32 v12, 5, v2
    v_bfe_u32 v13, v2, 4, 1
    v_lshlrev_b32 v14, 5, v3
    v_lshl_add_u32 v14, v13, 4, v14
    v_lshl_add_u32 v14, v12, 8, v14
    s_lshl_b32 s9, s6, 9
    v_add_u32 v14, s9, v14
    ds_write_b128 v14, v[112:115] offset:0
    s_waitcnt lgkmcnt(0)
    s_barrier
    s_cmp_lg_u32 s6, 0
    s_cbranch_scc1 K34_SKIP
    v_lshlrev_b32 v12, 2, v2
    ds_read_b32 v112, v12 offset:0
    ds_read_b32 v120, v12 offset:256
    ds_read_b32 v113, v12 offset:512
    ds_read_b32 v121, v12 offset:768
    ds_read_b32 v114, v12 offset:1024
    ds_read_b32 v122, v12 offset:1280
    ds_read_b32 v115, v12 offset:1536
    ds_read_b32 v123, v12 offset:1792
    ds_read_b32 v116, v12 offset:2048
    ds_read_b32 v124, v12 offset:2304
    ds_read_b32 v117, v12 offset:2560
    ds_read_b32 v125, v12 offset:2816
    ds_read_b32 v118, v12 offset:3072
    ds_read_b32 v126, v12 offset:3328
    ds_read_b32 v119, v12 offset:3584
    ds_read_b32 v127, v12 offset:3840
    s_waitcnt lgkmcnt(0)
    v_add_f32 v112, v112, v113
    v_add_f32 v114, v114, v115
    v_add_f32 v116, v116, v117
    v_add_f32 v118, v118, v119
    v_add_f32 v112, v112, v114
    v_add_f32 v116, v116, v118
    v_add_f32 v112, v112, v116
    v_add_f32 v120, v120, v121
    v_add_f32 v122, v122, v123
    v_add_f32 v124, v124, v125
    v_add_f32 v126, v126, v127
    v_add_f32 v120, v120, v122
    v_add_f32 v124, v124, v126
    v_add_f32 v120, v120, v124
    s_mov_b32 s9, 0x3b124925
    v_mul_f32 v112, s9, v112
    v_mul_f32 v120, s9, v120
    v_fma_f32 v120, -v112, v112, v120
    v_max_f32 v120, 0, v120
    s_waitcnt vmcnt(14)
    v_lshlrev_b32 v8, 16, v8
    v_add_f32 v112, v8, v112
    v_cvt_pk_bf16_f32 v13, v112, v120
    v_lshlrev_b32 v112, 16, v13
    v_and_b32 v120, s44, v13
    v_add_f32 v120, 0x3727c5ac, v120
    v_cvt_pk_bf16_f32 v120, v120, v120
    v_lshlrev_b32 v120, 16, v120
    v_sqrt_f32 v120, v120
    s_nop 0
    v_cvt_pk_bf16_f32 v120, v120, v120
    v_lshlrev_b32 v120, 16, v120
    v_rcp_f32 v120, v120
    ds_write_b32 v12, v112 offset:4096
    ds_write_b32 v12, v120 offset:4352
    s_waitcnt lgkmcnt(0)
K34_SKIP:
    s_barrier
    v_lshlrev_b32 v12, 5, v3
    ds_read_b128 v[104:107], v12 offset:4096
    ds_read_b128 v[108:111], v12 offset:4112
    ds_read_b128 v[112:115], v12 offset:4352
    ds_read_b128 v[116:119], v12 offset:4368
    s_movk_i32 s9, 160
    v_mul_lo_u32 v13, v4, s9
    v_lshl_add_u32 v13, v3, 4, v13
    v_add_u32 v13, 4608, v13
    s_waitcnt lgkmcnt(0)
    v_sub_f32 v48, v48, v104
    v_sub_f32 v49, v49, v105
    v_cvt_pk_bf16_f32 v12, v48, v49
    v_lshlrev_b32 v48, 16, v12
    v_and_b32 v49, v248, v12
    v_mul_f32 v48, v48, v112
    v_mul_f32 v49, v49, v113
    v_cvt_pk_bf16_f32 v16, v48, v49
    v_sub_f32 v50, v50, v106
    v_sub_f32 v51, v51, v107
    v_cvt_pk_bf16_f32 v14, v50, v51
    v_lshlrev_b32 v50, 16, v14
    v_and_b32 v51, v248, v14
    v_mul_f32 v50, v50, v114
    v_mul_f32 v51, v51, v115
    v_cvt_pk_bf16_f32 v17, v50, v51
    v_sub_f32 v52, v52, v108
    v_sub_f32 v53, v53, v109
    v_cvt_pk_bf16_f32 v12, v52, v53
    v_lshlrev_b32 v52, 16, v12
    v_and_b32 v53, v248, v12
    v_mul_f32 v52, v52, v116
    v_mul_f32 v53, v53, v117
    v_cvt_pk_bf16_f32 v18, v52, v53
    v_sub_f32 v54, v54, v110
    v_sub_f32 v55, v55, v111
    v_cvt_pk_bf16_f32 v14, v54, v55
    v_lshlrev_b32 v54, 16, v14
    v_and_b32 v55, v248, v14
    v_mul_f32 v54, v54, v118
    v_mul_f32 v55, v55, v119
    v_cvt_pk_bf16_f32 v19, v54, v55
    ds_write_b128 v13, v[16:19] offset:0
    buffer_load_dwordx4 v[184:187], v10, s[16:19], s37 offen offset:2048
    buffer_load_dwordx4 v[188:191], v10, s[16:19], s37 offen offset:3072
    v_sub_f32 v56, v56, v104
    v_sub_f32 v57, v57, v105
    v_cvt_pk_bf16_f32 v12, v56, v57
    v_lshlrev_b32 v56, 16, v12
    v_and_b32 v57, v248, v12
    v_mul_f32 v56, v56, v112
    v_mul_f32 v57, v57, v113
    v_cvt_pk_bf16_f32 v20, v56, v57
    v_sub_f32 v58, v58, v106
    v_sub_f32 v59, v59, v107
    v_cvt_pk_bf16_f32 v14, v58, v59
    v_lshlrev_b32 v58, 16, v14
    v_and_b32 v59, v248, v14
    v_mul_f32 v58, v58, v114
    v_mul_f32 v59, v59, v115
    v_cvt_pk_bf16_f32 v21, v58, v59
    v_sub_f32 v60, v60, v108
    v_sub_f32 v61, v61, v109
    v_cvt_pk_bf16_f32 v12, v60, v61
    v_lshlrev_b32 v60, 16, v12
    v_and_b32 v61, v248, v12
    v_mul_f32 v60, v60, v116
    v_mul_f32 v61, v61, v117
    v_cvt_pk_bf16_f32 v22, v60, v61
    v_sub_f32 v62, v62, v110
    v_sub_f32 v63, v63, v111
    v_cvt_pk_bf16_f32 v14, v62, v63
    v_lshlrev_b32 v62, 16, v14
    v_and_b32 v63, v248, v14
    v_mul_f32 v62, v62, v118
    v_mul_f32 v63, v63, v119
    v_cvt_pk_bf16_f32 v23, v62, v63
    ds_write_b128 v13, v[20:23] offset:10240
    buffer_load_dwordx4 v[192:195], v10, s[16:19], s38 offen offset:0
    buffer_load_dwordx4 v[196:199], v10, s[16:19], s38 offen offset:1024
    v_sub_f32 v64, v64, v104
    v_sub_f32 v65, v65, v105
    v_cvt_pk_bf16_f32 v12, v64, v65
    v_lshlrev_b32 v64, 16, v12
    v_and_b32 v65, v248, v12
    v_mul_f32 v64, v64, v112
    v_mul_f32 v65, v65, v113
    v_cvt_pk_bf16_f32 v24, v64, v65
    v_sub_f32 v66, v66, v106
    v_sub_f32 v67, v67, v107
    v_cvt_pk_bf16_f32 v14, v66, v67
    v_lshlrev_b32 v66, 16, v14
    v_and_b32 v67, v248, v14
    v_mul_f32 v66, v66, v114
    v_mul_f32 v67, v67, v115
    v_cvt_pk_bf16_f32 v25, v66, v67
    v_sub_f32 v68, v68, v108
    v_sub_f32 v69, v69, v109
    v_cvt_pk_bf16_f32 v12, v68, v69
    v_lshlrev_b32 v68, 16, v12
    v_and_b32 v69, v248, v12
    v_mul_f32 v68, v68, v116
    v_mul_f32 v69, v69, v117
    v_cvt_pk_bf16_f32 v26, v68, v69
    v_sub_f32 v70, v70, v110
    v_sub_f32 v71, v71, v111
    v_cvt_pk_bf16_f32 v14, v70, v71
    v_lshlrev_b32 v70, 16, v14
    v_and_b32 v71, v248, v14
    v_mul_f32 v70, v70, v118
    v_mul_f32 v71, v71, v119
    v_cvt_pk_bf16_f32 v27, v70, v71
    ds_write_b128 v13, v[24:27] offset:20480
    buffer_load_dwordx4 v[200:203], v10, s[16:19], s38 offen offset:2048
    buffer_load_dwordx4 v[204:207], v10, s[16:19], s38 offen offset:3072
    v_sub_f32 v72, v72, v104
    v_sub_f32 v73, v73, v105
    v_cvt_pk_bf16_f32 v12, v72, v73
    v_lshlrev_b32 v72, 16, v12
    v_and_b32 v73, v248, v12
    v_mul_f32 v72, v72, v112
    v_mul_f32 v73, v73, v113
    v_cvt_pk_bf16_f32 v28, v72, v73
    v_sub_f32 v74, v74, v106
    v_sub_f32 v75, v75, v107
    v_cvt_pk_bf16_f32 v14, v74, v75
    v_lshlrev_b32 v74, 16, v14
    v_and_b32 v75, v248, v14
    v_mul_f32 v74, v74, v114
    v_mul_f32 v75, v75, v115
    v_cvt_pk_bf16_f32 v29, v74, v75
    v_sub_f32 v76, v76, v108
    v_sub_f32 v77, v77, v109
    v_cvt_pk_bf16_f32 v12, v76, v77
    v_lshlrev_b32 v76, 16, v12
    v_and_b32 v77, v248, v12
    v_mul_f32 v76, v76, v116
    v_mul_f32 v77, v77, v117
    v_cvt_pk_bf16_f32 v30, v76, v77
    v_sub_f32 v78, v78, v110
    v_sub_f32 v79, v79, v111
    v_cvt_pk_bf16_f32 v14, v78, v79
    v_lshlrev_b32 v78, 16, v14
    v_and_b32 v79, v248, v14
    v_mul_f32 v78, v78, v118
    v_mul_f32 v79, v79, v119
    v_cvt_pk_bf16_f32 v31, v78, v79
    ds_write_b128 v13, v[28:31] offset:30720
    buffer_load_dwordx4 v[208:211], v10, s[16:19], s39 offen offset:0
    buffer_load_dwordx4 v[212:215], v10, s[16:19], s39 offen offset:1024
    v_sub_f32 v80, v80, v104
    v_sub_f32 v81, v81, v105
    v_cvt_pk_bf16_f32 v12, v80, v81
    v_lshlrev_b32 v80, 16, v12
    v_and_b32 v81, v248, v12
    v_mul_f32 v80, v80, v112
    v_mul_f32 v81, v81, v113
    v_cvt_pk_bf16_f32 v32, v80, v81
    v_sub_f32 v82, v82, v106
    v_sub_f32 v83, v83, v107
    v_cvt_pk_bf16_f32 v14, v82, v83
    v_lshlrev_b32 v82, 16, v14
    v_and_b32 v83, v248, v14
    v_mul_f32 v82, v82, v114
    v_mul_f32 v83, v83, v115
    v_cvt_pk_bf16_f32 v33, v82, v83
    v_sub_f32 v84, v84, v108
    v_sub_f32 v85, v85, v109
    v_cvt_pk_bf16_f32 v12, v84, v85
    v_lshlrev_b32 v84, 16, v12
    v_and_b32 v85, v248, v12
    v_mul_f32 v84, v84, v116
    v_mul_f32 v85, v85, v117
    v_cvt_pk_bf16_f32 v34, v84, v85
    v_sub_f32 v86, v86, v110
    v_sub_f32 v87, v87, v111
    v_cvt_pk_bf16_f32 v14, v86, v87
    v_lshlrev_b32 v86, 16, v14
    v_and_b32 v87, v248, v14
    v_mul_f32 v86, v86, v118
    v_mul_f32 v87, v87, v119
    v_cvt_pk_bf16_f32 v35, v86, v87
    ds_write_b128 v13, v[32:35] offset:40960
    buffer_load_dwordx4 v[216:219], v10, s[16:19], s39 offen offset:2048
    buffer_load_dwordx4 v[220:223], v10, s[16:19], s39 offen offset:3072
    v_sub_f32 v88, v88, v104
    v_sub_f32 v89, v89, v105
    v_cvt_pk_bf16_f32 v12, v88, v89
    v_lshlrev_b32 v88, 16, v12
    v_and_b32 v89, v248, v12
    v_mul_f32 v88, v88, v112
    v_mul_f32 v89, v89, v113
    v_cvt_pk_bf16_f32 v36, v88, v89
    v_sub_f32 v90, v90, v106
    v_sub_f32 v91, v91, v107
    v_cvt_pk_bf16_f32 v14, v90, v91
    v_lshlrev_b32 v90, 16, v14
    v_and_b32 v91, v248, v14
    v_mul_f32 v90, v90, v114
    v_mul_f32 v91, v91, v115
    v_cvt_pk_bf16_f32 v37, v90, v91
    v_sub_f32 v92, v92, v108
    v_sub_f32 v93, v93, v109
    v_cvt_pk_bf16_f32 v12, v92, v93
    v_lshlrev_b32 v92, 16, v12
    v_and_b32 v93, v248, v12
    v_mul_f32 v92, v92, v116
    v_mul_f32 v93, v93, v117
    v_cvt_pk_bf16_f32 v38, v92, v93
    v_sub_f32 v94, v94, v110
    v_sub_f32 v95, v95, v111
    v_cvt_pk_bf16_f32 v14, v94, v95
    v_lshlrev_b32 v94, 16, v14
    v_and_b32 v95, v248, v14
    v_mul_f32 v94, v94, v118
    v_mul_f32 v95, v95, v119
    v_cvt_pk_bf16_f32 v39, v94, v95
    ds_write_b128 v13, v[36:39] offset:51200
    buffer_load_dwordx4 v[224:227], v10, s[16:19], s40 offen offset:0
    buffer_load_dwordx4 v[228:231], v10, s[16:19], s40 offen offset:1024
    v_sub_f32 v96, v96, v104
    v_sub_f32 v97, v97, v105
    v_cvt_pk_bf16_f32 v12, v96, v97
    v_lshlrev_b32 v96, 16, v12
    v_and_b32 v97, v248, v12
    v_mul_f32 v96, v96, v112
    v_mul_f32 v97, v97, v113
    v_cvt_pk_bf16_f32 v40, v96, v97
    v_sub_f32 v98, v98, v106
    v_sub_f32 v99, v99, v107
    v_cvt_pk_bf16_f32 v14, v98, v99
    v_lshlrev_b32 v98, 16, v14
    v_and_b32 v99, v248, v14
    v_mul_f32 v98, v98, v114
    v_mul_f32 v99, v99, v115
    v_cvt_pk_bf16_f32 v41, v98, v99
    v_sub_f32 v100, v100, v108
    v_sub_f32 v101, v101, v109
    v_cvt_pk_bf16_f32 v12, v100, v101
    v_lshlrev_b32 v100, 16, v12
    v_and_b32 v101, v248, v12
    v_mul_f32 v100, v100, v116
    v_mul_f32 v101, v101, v117
    v_cvt_pk_bf16_f32 v42, v100, v101
    v_sub_f32 v102, v102, v110
    v_sub_f32 v103, v103, v111
    v_cvt_pk_bf16_f32 v14, v102, v103
    v_lshlrev_b32 v102, 16, v14
    v_and_b32 v103, v248, v14
    v_mul_f32 v102, v102, v118
    v_mul_f32 v103, v103, v119
    v_cvt_pk_bf16_f32 v43, v102, v103
    ds_write_b128 v13, v[40:43] offset:61440
    buffer_load_dwordx4 v[232:235], v10, s[16:19], s40 offen offset:2048
    buffer_load_dwordx4 v[236:239], v10, s[16:19], s40 offen offset:3072
    v_lshrrev_b32 v4, 4, v2
    v_bfe_u32 v5, v2, 2, 2
    v_lshl_add_u32 v4, v4, 2, v5
    v_mul_lo_u32 v4, v4, s9
    v_and_b32 v5, 3, v2
    v_lshl_add_u32 v4, v5, 3, v4
    v_add_u32 v4, 4608, v4
    v_add_u32 v5, 35840, v4
    v_mov_b32 v96, 0
    v_mov_b32 v97, 0
    v_mov_b32 v98, 0
    v_mov_b32 v99, 0
    v_mov_b32 v100, 0
    v_mov_b32 v101, 0
    v_mov_b32 v102, 0
    v_mov_b32 v103, 0
    v_mov_b32 v104, 0
    v_mov_b32 v105, 0
    v_mov_b32 v106, 0
    v_mov_b32 v107, 0
    v_mov_b32 v108, 0
    v_mov_b32 v109, 0
    v_mov_b32 v110, 0
    v_mov_b32 v111, 0
    v_mov_b32 v112, 0
    v_mov_b32 v113, 0
    v_mov_b32 v114, 0
    v_mov_b32 v115, 0
    v_mov_b32 v116, 0
    v_mov_b32 v117, 0
    v_mov_b32 v118, 0
    v_mov_b32 v119, 0
    v_mov_b32 v120, 0
    v_mov_b32 v121, 0
    v_mov_b32 v122, 0
    v_mov_b32 v123, 0
    v_mov_b32 v124, 0
    v_mov_b32 v125, 0
    v_mov_b32 v126, 0
    v_mov_b32 v127, 0
    s_add_u32 s48, s32, 0xc00000
    s_addc_u32 s49, s33, 0
    s_mov_b32 s50, 0x188000
    s_mov_b32 s51, 0x00020000
    s_mul_i32 s8, s4, 229376
    s_lshl_b32 s10, s6, 12
    s_add_u32 s8, s8, s10
    v_add_u32 v11, s8, v9
    s_add_u32 s8, s4, 0
    s_cmp_ge_u32 s8, 7
    s_cselect_b32 s10, 7, 0
    s_sub_u32 s8, s8, s10
    s_lshl_b32 s61, s8, 15
    s_add_u32 s8, s4, 1
    s_cmp_ge_u32 s8, 7
    s_cselect_b32 s10, 7, 0
    s_sub_u32 s8, s8, s10
    s_lshl_b32 s62, s8, 15
    s_add_u32 s8, s4, 2
    s_cmp_ge_u32 s8, 7
    s_cselect_b32 s10, 7, 0
    s_sub_u32 s8, s8, s10
    s_lshl_b32 s63, s8, 15
    s_add_u32 s8, s4, 3
    s_cmp_ge_u32 s8, 7
    s_cselect_b32 s10, 7, 0
    s_sub_u32 s8, s8, s10
    s_lshl_b32 s64, s8, 15
    s_add_u32 s8, s4, 4
    s_cmp_ge_u32 s8, 7
    s_cselect_b32 s10, 7, 0
    s_sub_u32 s8, s8, s10
    s_lshl_b32 s65, s8, 15
    s_add_u32 s8, s4, 5
    s_cmp_ge_u32 s8, 7
    s_cselect_b32 s10, 7, 0
    s_sub_u32 s8, s8, s10
    s_lshl_b32 s66, s8, 15
    s_add_u32 s8, s4, 6
    s_cmp_ge_u32 s8, 7
    s_cselect_b32 s10, 7, 0
    s_sub_u32 s8, s8, s10
    s_lshl_b32 s67, s8, 15
    s_waitcnt lgkmcnt(0)
    s_barrier
    ds_read_b64_tr_b16 v[16:17], v4 offset:0
    ds_read_b64_tr_b16 v[18:19], v4 offset:2560
    ds_read_b64_tr_b16 v[20:21], v4 offset:32
    ds_read_b64_tr_b16 v[22:23], v4 offset:2592
    ds_read_b64_tr_b16 v[24:25], v4 offset:64
    ds_read_b64_tr_b16 v[26:27], v4 offset:2624
    ds_read_b64_tr_b16 v[28:29], v4 offset:96
    ds_read_b64_tr_b16 v[30:31], v4 offset:2656
    ds_read_b64_tr_b16 v[32:33], v4 offset:5120
    ds_read_b64_tr_b16 v[34:35], v4 offset:7680
    ds_read_b64_tr_b16 v[36:37], v4 offset:5152
    ds_read_b64_tr_b16 v[38:39], v4 offset:7712
    ds_read_b64_tr_b16 v[40:41], v4 offset:5184
    ds_read_b64_tr_b16 v[42:43], v4 offset:7744
    ds_read_b64_tr_b16 v[44:45], v4 offset:5216
    ds_read_b64_tr_b16 v[46:47], v4 offset:7776
    s_waitcnt vmcnt(26) lgkmcnt(8)
    v_mfma_f32_16x16x32_bf16 v[96:99], v[128:131], v[16:19], v[96:99]
    v_mfma_f32_16x16x32_bf16 v[112:115], v[132:135], v[16:19], v[112:115]
    v_mfma_f32_16x16x32_bf16 v[100:103], v[128:131], v[20:23], v[100:103]
    v_mfma_f32_16x16x32_bf16 v[116:119], v[132:135], v[20:23], v[116:119]
    v_mfma_f32_16x16x32_bf16 v[104:107], v[128:131], v[24:27], v[104:107]
    v_mfma_f32_16x16x32_bf16 v[120:123], v[132:135], v[24:27], v[120:123]
    v_mfma_f32_16x16x32_bf16 v[108:111], v[128:131], v[28:31], v[108:111]
    v_mfma_f32_16x16x32_bf16 v[124:127], v[132:135], v[28:31], v[124:127]
    ds_read_b64_tr_b16 v[16:17], v4 offset:10240
    ds_read_b64_tr_b16 v[18:19], v4 offset:12800
    ds_read_b64_tr_b16 v[20:21], v4 offset:10272
    ds_read_b64_tr_b16 v[22:23], v4 offset:12832
    ds_read_b64_tr_b16 v[24:25], v4 offset:10304
    ds_read_b64_tr_b16 v[26:27], v4 offset:12864
    ds_read_b64_tr_b16 v[28:29], v4 offset:10336
    ds_read_b64_tr_b16 v[30:31], v4 offset:12896
    s_waitcnt vmcnt(24) lgkmcnt(8)
    v_mfma_f32_16x16x32_bf16 v[96:99], v[136:139], v[32:35], v[96:99]
    v_mfma_f32_16x16x32_bf16 v[112:115], v[140:143], v[32:35], v[112:115]
    v_mfma_f32_16x16x32_bf16 v[100:103], v[136:139], v[36:39], v[100:103]
    v_mfma_f32_16x16x32_bf16 v[116:119], v[140:143], v[36:39], v[116:119]
    v_mfma_f32_16x16x32_bf16 v[104:107], v[136:139], v[40:43], v[104:107]
    v_mfma_f32_16x16x32_bf16 v[120:123], v[140:143], v[40:43], v[120:123]
    v_mfma_f32_16x16x32_bf16 v[108:111], v[136:139], v[44:47], v[108:111]
    v_mfma_f32_16x16x32_bf16 v[124:127], v[140:143], v[44:47], v[124:127]
    buffer_load_dwordx4 v[128:131], v11, s[48:51], s61 offen offset:0
    buffer_load_dwordx4 v[132:135], v11, s[48:51], s61 offen offset:1024
    ds_read_b64_tr_b16 v[32:33], v4 offset:15360
    ds_read_b64_tr_b16 v[34:35], v4 offset:17920
    ds_read_b64_tr_b16 v[36:37], v4 offset:15392
    ds_read_b64_tr_b16 v[38:39], v4 offset:17952
    ds_read_b64_tr_b16 v[40:41], v4 offset:15424
    ds_read_b64_tr_b16 v[42:43], v4 offset:17984
    ds_read_b64_tr_b16 v[44:45], v4 offset:15456
    ds_read_b64_tr_b16 v[46:47], v4 offset:18016
    s_waitcnt vmcnt(24) lgkmcnt(8)
    v_mfma_f32_16x16x32_bf16 v[96:99], v[144:147], v[16:19], v[96:99]
    v_mfma_f32_16x16x32_bf16 v[112:115], v[148:151], v[16:19], v[112:115]
    v_mfma_f32_16x16x32_bf16 v[100:103], v[144:147], v[20:23], v[100:103]
    v_mfma_f32_16x16x32_bf16 v[116:119], v[148:151], v[20:23], v[116:119]
    v_mfma_f32_16x16x32_bf16 v[104:107], v[144:147], v[24:27], v[104:107]
    v_mfma_f32_16x16x32_bf16 v[120:123], v[148:151], v[24:27], v[120:123]
    v_mfma_f32_16x16x32_bf16 v[108:111], v[144:147], v[28:31], v[108:111]
    v_mfma_f32_16x16x32_bf16 v[124:127], v[148:151], v[28:31], v[124:127]
    buffer_load_dwordx4 v[136:139], v11, s[48:51], s61 offen offset:2048
    buffer_load_dwordx4 v[140:143], v11, s[48:51], s61 offen offset:3072
    ds_read_b64_tr_b16 v[16:17], v4 offset:20480
    ds_read_b64_tr_b16 v[18:19], v4 offset:23040
    ds_read_b64_tr_b16 v[20:21], v4 offset:20512
    ds_read_b64_tr_b16 v[22:23], v4 offset:23072
    ds_read_b64_tr_b16 v[24:25], v4 offset:20544
    ds_read_b64_tr_b16 v[26:27], v4 offset:23104
    ds_read_b64_tr_b16 v[28:29], v4 offset:20576
    ds_read_b64_tr_b16 v[30:31], v4 offset:23136
    s_waitcnt vmcnt(24) lgkmcnt(8)
    v_mfma_f32_16x16x32_bf16 v[96:99], v[152:155], v[32:35], v[96:99]
    v_mfma_f32_16x16x32_bf16 v[112:115], v[156:159], v[32:35], v[112:115]
    v_mfma_f32_16x16x32_bf16 v[100:103], v[152:155], v[36:39], v[100:103]
    v_mfma_f32_16x16x32_bf16 v[116:119], v[156:159], v[36:39], v[116:119]
    v_mfma_f32_16x16x32_bf16 v[104:107], v[152:155], v[40:43], v[104:107]
    v_mfma_f32_16x16x32_bf16 v[120:123], v[156:159], v[40:43], v[120:123]
    v_mfma_f32_16x16x32_bf16 v[108:111], v[152:155], v[44:47], v[108:111]
    v_mfma_f32_16x16x32_bf16 v[124:127], v[156:159], v[44:47], v[124:127]
    buffer_load_dwordx4 v[144:147], v11, s[48:51], s62 offen offset:0
    buffer_load_dwordx4 v[148:151], v11, s[48:51], s62 offen offset:1024
    ds_read_b64_tr_b16 v[32:33], v4 offset:25600
    ds_read_b64_tr_b16 v[34:35], v4 offset:28160
    ds_read_b64_tr_b16 v[36:37], v4 offset:25632
    ds_read_b64_tr_b16 v[38:39], v4 offset:28192
    ds_read_b64_tr_b16 v[40:41], v4 offset:25664
    ds_read_b64_tr_b16 v[42:43], v4 offset:28224
    ds_read_b64_tr_b16 v[44:45], v4 offset:25696
    ds_read_b64_tr_b16 v[46:47], v4 offset:28256
    s_waitcnt vmcnt(24) lgkmcnt(8)
    v_mfma_f32_16x16x32_bf16 v[96:99], v[160:163], v[16:19], v[96:99]
    v_mfma_f32_16x16x32_bf16 v[112:115], v[164:167], v[16:19], v[112:115]
    v_mfma_f32_16x16x32_bf16 v[100:103], v[160:163], v[20:23], v[100:103]
    v_mfma_f32_16x16x32_bf16 v[116:119], v[164:167], v[20:23], v[116:119]
    v_mfma_f32_16x16x32_bf16 v[104:107], v[160:163], v[24:27], v[104:107]
    v_mfma_f32_16x16x32_bf16 v[120:123], v[164:167], v[24:27], v[120:123]
    v_mfma_f32_16x16x32_bf16 v[108:111], v[160:163], v[28:31], v[108:111]
    v_mfma_f32_16x16x32_bf16 v[124:127], v[164:167], v[28:31], v[124:127]
    buffer_load_dwordx4 v[152:155], v11, s[48:51], s62 offen offset:2048
    buffer_load_dwordx4 v[156:159], v11, s[48:51], s62 offen offset:3072
    ds_read_b64_tr_b16 v[16:17], v4 offset:30720
    ds_read_b64_tr_b16 v[18:19], v4 offset:33280
    ds_read_b64_tr_b16 v[20:21], v4 offset:30752
    ds_read_b64_tr_b16 v[22:23], v4 offset:33312
    ds_read_b64_tr_b16 v[24:25], v4 offset:30784
    ds_read_b64_tr_b16 v[26:27], v4 offset:33344
    ds_read_b64_tr_b16 v[28:29], v4 offset:30816
    ds_read_b64_tr_b16 v[30:31], v4 offset:33376
    s_waitcnt vmcnt(24) lgkmcnt(8)
    v_mfma_f32_16x16x32_bf16 v[96:99], v[168:171], v[32:35], v[96:99]
    v_mfma_f32_16x16x32_bf16 v[112:115], v[172:175], v[32:35], v[112:115]
    v_mfma_f32_16x16x32_bf16 v[100:103], v[168:171], v[36:39], v[100:103]
    v_mfma_f32_16x16x32_bf16 v[116:119], v[172:175], v[36:39], v[116:119]
    v_mfma_f32_16x16x32_bf16 v[104:107], v[168:171], v[40:43], v[104:107]
    v_mfma_f32_16x16x32_bf16 v[120:123], v[172:175], v[40:43], v[120:123]
    v_mfma_f32_16x16x32_bf16 v[108:111], v[168:171], v[44:47], v[108:111]
    v_mfma_f32_16x16x32_bf16 v[124:127], v[172:175], v[44:47], v[124:127]
    buffer_load_dwordx4 v[160:163], v11, s[48:51], s63 offen offset:0
    buffer_load_dwordx4 v[164:167], v11, s[48:51], s63 offen offset:1024
    ds_read_b64_tr_b16 v[32:33], v5 offset:0
    ds_read_b64_tr_b16 v[34:35], v5 offset:2560
    ds_read_b64_tr_b16 v[36:37], v5 offset:32
    ds_read_b64_tr_b16 v[38:39], v5 offset:2592
    ds_read_b64_tr_b16 v[40:41], v5 offset:64
    ds_read_b64_tr_b16 v[42:43], v5 offset:2624
    ds_read_b64_tr_b16 v[44:45], v5 offset:96
    ds_read_b64_tr_b16 v[46:47], v5 offset:2656
    s_waitcnt vmcnt(24) lgkmcnt(8)
    v_mfma_f32_16x16x32_bf16 v[96:99], v[176:179], v[16:19], v[96:99]
    v_mfma_f32_16x16x32_bf16 v[112:115], v[180:183], v[16:19], v[112:115]
    v_mfma_f32_16x16x32_bf16 v[100:103], v[176:179], v[20:23], v[100:103]
    v_mfma_f32_16x16x32_bf16 v[116:119], v[180:183], v[20:23], v[116:119]
    v_mfma_f32_16x16x32_bf16 v[104:107], v[176:179], v[24:27], v[104:107]
    v_mfma_f32_16x16x32_bf16 v[120:123], v[180:183], v[24:27], v[120:123]
    v_mfma_f32_16x16x32_bf16 v[108:111], v[176:179], v[28:31], v[108:111]
    v_mfma_f32_16x16x32_bf16 v[124:127], v[180:183], v[28:31], v[124:127]
    buffer_load_dwordx4 v[168:171], v11, s[48:51], s63 offen offset:2048
    buffer_load_dwordx4 v[172:175], v11, s[48:51], s63 offen offset:3072
    ds_read_b64_tr_b16 v[16:17], v5 offset:5120
    ds_read_b64_tr_b16 v[18:19], v5 offset:7680
    ds_read_b64_tr_b16 v[20:21], v5 offset:5152
    ds_read_b64_tr_b16 v[22:23], v5 offset:7712
    ds_read_b64_tr_b16 v[24:25], v5 offset:5184
    ds_read_b64_tr_b16 v[26:27], v5 offset:7744
    ds_read_b64_tr_b16 v[28:29], v5 offset:5216
    ds_read_b64_tr_b16 v[30:31], v5 offset:7776
    s_waitcnt vmcnt(24) lgkmcnt(8)
    v_mfma_f32_16x16x32_bf16 v[96:99], v[184:187], v[32:35], v[96:99]
    v_mfma_f32_16x16x32_bf16 v[112:115], v[188:191], v[32:35], v[112:115]
    v_mfma_f32_16x16x32_bf16 v[100:103], v[184:187], v[36:39], v[100:103]
    v_mfma_f32_16x16x32_bf16 v[116:119], v[188:191], v[36:39], v[116:119]
    v_mfma_f32_16x16x32_bf16 v[104:107], v[184:187], v[40:43], v[104:107]
    v_mfma_f32_16x16x32_bf16 v[120:123], v[188:191], v[40:43], v[120:123]
    v_mfma_f32_16x16x32_bf16 v[108:111], v[184:187], v[44:47], v[108:111]
    v_mfma_f32_16x16x32_bf16 v[124:127], v[188:191], v[44:47], v[124:127]
    buffer_load_dwordx4 v[176:179], v11, s[48:51], s64 offen offset:0
    buffer_load_dwordx4 v[180:183], v11, s[48:51], s64 offen offset:1024
    ds_read_b64_tr_b16 v[32:33], v5 offset:10240
    ds_read_b64_tr_b16 v[34:35], v5 offset:12800
    ds_read_b64_tr_b16 v[36:37], v5 offset:10272
    ds_read_b64_tr_b16 v[38:39], v5 offset:12832
    ds_read_b64_tr_b16 v[40:41], v5 offset:10304
    ds_read_b64_tr_b16 v[42:43], v5 offset:12864
    ds_read_b64_tr_b16 v[44:45], v5 offset:10336
    ds_read_b64_tr_b16 v[46:47], v5 offset:12896
    s_waitcnt vmcnt(24) lgkmcnt(8)
    v_mfma_f32_16x16x32_bf16 v[96:99], v[192:195], v[16:19], v[96:99]
    v_mfma_f32_16x16x32_bf16 v[112:115], v[196:199], v[16:19], v[112:115]
    v_mfma_f32_16x16x32_bf16 v[100:103], v[192:195], v[20:23], v[100:103]
    v_mfma_f32_16x16x32_bf16 v[116:119], v[196:199], v[20:23], v[116:119]
    v_mfma_f32_16x16x32_bf16 v[104:107], v[192:195], v[24:27], v[104:107]
    v_mfma_f32_16x16x32_bf16 v[120:123], v[196:199], v[24:27], v[120:123]
    v_mfma_f32_16x16x32_bf16 v[108:111], v[192:195], v[28:31], v[108:111]
    v_mfma_f32_16x16x32_bf16 v[124:127], v[196:199], v[28:31], v[124:127]
    buffer_load_dwordx4 v[184:187], v11, s[48:51], s64 offen offset:2048
    buffer_load_dwordx4 v[188:191], v11, s[48:51], s64 offen offset:3072
    ds_read_b64_tr_b16 v[16:17], v5 offset:15360
    ds_read_b64_tr_b16 v[18:19], v5 offset:17920
    ds_read_b64_tr_b16 v[20:21], v5 offset:15392
    ds_read_b64_tr_b16 v[22:23], v5 offset:17952
    ds_read_b64_tr_b16 v[24:25], v5 offset:15424
    ds_read_b64_tr_b16 v[26:27], v5 offset:17984
    ds_read_b64_tr_b16 v[28:29], v5 offset:15456
    ds_read_b64_tr_b16 v[30:31], v5 offset:18016
    s_waitcnt vmcnt(24) lgkmcnt(8)
    v_mfma_f32_16x16x32_bf16 v[96:99], v[200:203], v[32:35], v[96:99]
    v_mfma_f32_16x16x32_bf16 v[112:115], v[204:207], v[32:35], v[112:115]
    v_mfma_f32_16x16x32_bf16 v[100:103], v[200:203], v[36:39], v[100:103]
    v_mfma_f32_16x16x32_bf16 v[116:119], v[204:207], v[36:39], v[116:119]
    v_mfma_f32_16x16x32_bf16 v[104:107], v[200:203], v[40:43], v[104:107]
    v_mfma_f32_16x16x32_bf16 v[120:123], v[204:207], v[40:43], v[120:123]
    v_mfma_f32_16x16x32_bf16 v[108:111], v[200:203], v[44:47], v[108:111]
    v_mfma_f32_16x16x32_bf16 v[124:127], v[204:207], v[44:47], v[124:127]
    buffer_load_dwordx4 v[192:195], v11, s[48:51], s65 offen offset:0
    buffer_load_dwordx4 v[196:199], v11, s[48:51], s65 offen offset:1024
    ds_read_b64_tr_b16 v[32:33], v5 offset:20480
    ds_read_b64_tr_b16 v[34:35], v5 offset:23040
    ds_read_b64_tr_b16 v[36:37], v5 offset:20512
    ds_read_b64_tr_b16 v[38:39], v5 offset:23072
    ds_read_b64_tr_b16 v[40:41], v5 offset:20544
    ds_read_b64_tr_b16 v[42:43], v5 offset:23104
    ds_read_b64_tr_b16 v[44:45], v5 offset:20576
    ds_read_b64_tr_b16 v[46:47], v5 offset:23136
    s_waitcnt vmcnt(24) lgkmcnt(8)
    v_mfma_f32_16x16x32_bf16 v[96:99], v[208:211], v[16:19], v[96:99]
    v_mfma_f32_16x16x32_bf16 v[112:115], v[212:215], v[16:19], v[112:115]
    v_mfma_f32_16x16x32_bf16 v[100:103], v[208:211], v[20:23], v[100:103]
    v_mfma_f32_16x16x32_bf16 v[116:119], v[212:215], v[20:23], v[116:119]
    v_mfma_f32_16x16x32_bf16 v[104:107], v[208:211], v[24:27], v[104:107]
    v_mfma_f32_16x16x32_bf16 v[120:123], v[212:215], v[24:27], v[120:123]
    v_mfma_f32_16x16x32_bf16 v[108:111], v[208:211], v[28:31], v[108:111]
    v_mfma_f32_16x16x32_bf16 v[124:127], v[212:215], v[28:31], v[124:127]
    buffer_load_dwordx4 v[200:203], v11, s[48:51], s65 offen offset:2048
    buffer_load_dwordx4 v[204:207], v11, s[48:51], s65 offen offset:3072
    ds_read_b64_tr_b16 v[16:17], v5 offset:25600
    ds_read_b64_tr_b16 v[18:19], v5 offset:28160
    ds_read_b64_tr_b16 v[20:21], v5 offset:25632
    ds_read_b64_tr_b16 v[22:23], v5 offset:28192
    ds_read_b64_tr_b16 v[24:25], v5 offset:25664
    ds_read_b64_tr_b16 v[26:27], v5 offset:28224
    ds_read_b64_tr_b16 v[28:29], v5 offset:25696
    ds_read_b64_tr_b16 v[30:31], v5 offset:28256
    s_waitcnt vmcnt(24) lgkmcnt(8)
    v_mfma_f32_16x16x32_bf16 v[96:99], v[216:219], v[32:35], v[96:99]
    v_mfma_f32_16x16x32_bf16 v[112:115], v[220:223], v[32:35], v[112:115]
    v_mfma_f32_16x16x32_bf16 v[100:103], v[216:219], v[36:39], v[100:103]
    v_mfma_f32_16x16x32_bf16 v[116:119], v[220:223], v[36:39], v[116:119]
    v_mfma_f32_16x16x32_bf16 v[104:107], v[216:219], v[40:43], v[104:107]
    v_mfma_f32_16x16x32_bf16 v[120:123], v[220:223], v[40:43], v[120:123]
    v_mfma_f32_16x16x32_bf16 v[108:111], v[216:219], v[44:47], v[108:111]
    v_mfma_f32_16x16x32_bf16 v[124:127], v[220:223], v[44:47], v[124:127]
    ds_read_b64_tr_b16 v[32:33], v5 offset:30720
    ds_read_b64_tr_b16 v[34:35], v5 offset:33280
    ds_read_b64_tr_b16 v[36:37], v5 offset:30752
    ds_read_b64_tr_b16 v[38:39], v5 offset:33312
    ds_read_b64_tr_b16 v[40:41], v5 offset:30784
    ds_read_b64_tr_b16 v[42:43], v5 offset:33344
    ds_read_b64_tr_b16 v[44:45], v5 offset:30816
    ds_read_b64_tr_b16 v[46:47], v5 offset:33376
    s_waitcnt vmcnt(22) lgkmcnt(8)
    v_mfma_f32_16x16x32_bf16 v[96:99], v[224:227], v[16:19], v[96:99]
    v_mfma_f32_16x16x32_bf16 v[112:115], v[228:231], v[16:19], v[112:115]
    v_mfma_f32_16x16x32_bf16 v[100:103], v[224:227], v[20:23], v[100:103]
    v_mfma_f32_16x16x32_bf16 v[116:119], v[228:231], v[20:23], v[116:119]
    v_mfma_f32_16x16x32_bf16 v[104:107], v[224:227], v[24:27], v[104:107]
    v_mfma_f32_16x16x32_bf16 v[120:123], v[228:231], v[24:27], v[120:123]
    v_mfma_f32_16x16x32_bf16 v[108:111], v[224:227], v[28:31], v[108:111]
    v_mfma_f32_16x16x32_bf16 v[124:127], v[228:231], v[28:31], v[124:127]
    s_waitcnt vmcnt(20) lgkmcnt(0)
    v_mfma_f32_16x16x32_bf16 v[96:99], v[232:235], v[32:35], v[96:99]
    v_mfma_f32_16x16x32_bf16 v[112:115], v[236:239], v[32:35], v[112:115]
    v_mfma_f32_16x16x32_bf16 v[100:103], v[232:235], v[36:39], v[100:103]
    v_mfma_f32_16x16x32_bf16 v[116:119], v[236:239], v[36:39], v[116:119]
    v_mfma_f32_16x16x32_bf16 v[104:107], v[232:235], v[40:43], v[104:107]
    v_mfma_f32_16x16x32_bf16 v[120:123], v[236:239], v[40:43], v[120:123]
    v_mfma_f32_16x16x32_bf16 v[108:111], v[232:235], v[44:47], v[108:111]
    v_mfma_f32_16x16x32_bf16 v[124:127], v[236:239], v[44:47], v[124:127]
    s_mul_i32 s8, s3, 229376
    s_lshl_b32 s9, s7, 10
    s_add_u32 s8, s8, s9
    v_add_u32 v10, s8, v9
    s_add_u32 s46, s32, 0x1000000
    s_addc_u32 s47, s33, 0
    v_cvt_pk_bf16_f32 v80, v96, v97
    v_cvt_pk_bf16_f32 v81, v98, v99
    v_cvt_pk_bf16_f32 v82, v112, v113
    v_cvt_pk_bf16_f32 v83, v114, v115
    v_pk_max_i16 v80, v80, 0
    v_pk_max_i16 v81, v81, 0
    v_pk_max_i16 v82, v82, 0
    v_pk_max_i16 v83, v83, 0
    global_store_dwordx4 v10, v[80:83], s[46:47] sc1
    v_cvt_pk_bf16_f32 v84, v100, v101
    v_cvt_pk_bf16_f32 v85, v102, v103
    v_cvt_pk_bf16_f32 v86, v116, v117
    v_cvt_pk_bf16_f32 v87, v118, v119
    v_pk_max_i16 v84, v84, 0
    v_pk_max_i16 v85, v85, 0
    v_pk_max_i16 v86, v86, 0
    v_pk_max_i16 v87, v87, 0
    v_add_u32 v10, 57344, v10
    global_store_dwordx4 v10, v[84:87], s[46:47] sc1
    v_cvt_pk_bf16_f32 v88, v104, v105
    v_cvt_pk_bf16_f32 v89, v106, v107
    v_cvt_pk_bf16_f32 v90, v120, v121
    v_cvt_pk_bf16_f32 v91, v122, v123
    v_pk_max_i16 v88, v88, 0
    v_pk_max_i16 v89, v89, 0
    v_pk_max_i16 v90, v90, 0
    v_pk_max_i16 v91, v91, 0
    v_add_u32 v10, 57344, v10
    global_store_dwordx4 v10, v[88:91], s[46:47] sc1
    v_cvt_pk_bf16_f32 v92, v108, v109
    v_cvt_pk_bf16_f32 v93, v110, v111
    v_cvt_pk_bf16_f32 v94, v124, v125
    v_cvt_pk_bf16_f32 v95, v126, v127
    v_pk_max_i16 v92, v92, 0
    v_pk_max_i16 v93, v93, 0
    v_pk_max_i16 v94, v94, 0
    v_pk_max_i16 v95, v95, 0
    v_add_u32 v10, 57344, v10
    global_store_dwordx4 v10, v[92:95], s[46:47] sc1
    v_lshrrev_b32 v3, 3, v0
    v_and_b32 v4, 7, v0
    s_lshl_b32 s8, s4, 18
    s_lshl_b32 s9, s3, 7
    s_add_u32 s8, s8, s9
    v_lshlrev_b32 v5, 15, v4
    v_lshl_add_u32 v5, v3, 1, v5
    v_add_u32 v5, s8, v5
    v_mov_b32 v16, 0
    v_mov_b32 v17, 0
    v_mov_b32 v18, 0
    v_mov_b32 v19, 0
    v_mov_b32 v20, 0
    v_mov_b32 v21, 0
    v_mov_b32 v22, 0
    v_mov_b32 v23, 0
    v_mov_b32 v24, 0
    v_mov_b32 v25, 0
    v_mov_b32 v26, 0
    v_mov_b32 v27, 0
    v_mov_b32 v28, 0
    v_mov_b32 v29, 0
    v_mov_b32 v30, 0
    v_mov_b32 v31, 0
    v_mov_b32 v32, 0
    v_mov_b32 v33, 0
    v_mov_b32 v34, 0
    v_mov_b32 v35, 0
    v_mov_b32 v36, 0
    v_mov_b32 v37, 0
    v_mov_b32 v38, 0
    v_mov_b32 v39, 0
    v_mov_b32 v40, 0
    v_mov_b32 v41, 0
    v_mov_b32 v42, 0
    v_mov_b32 v43, 0
    v_mov_b32 v44, 0
    v_mov_b32 v45, 0
    v_mov_b32 v46, 0
    v_mov_b32 v47, 0
    v_mov_b32 v48, 0
    v_mov_b32 v49, 0
    v_mov_b32 v50, 0
    v_mov_b32 v51, 0
    v_mov_b32 v52, 0
    v_mov_b32 v53, 0
    v_mov_b32 v54, 0
    v_mov_b32 v55, 0
    v_mov_b32 v56, 0
    v_mov_b32 v57, 0
    v_mov_b32 v58, 0
    v_mov_b32 v59, 0
    v_mov_b32 v60, 0
    v_mov_b32 v61, 0
    v_mov_b32 v62, 0
    v_mov_b32 v63, 0
    v_mov_b32 v64, 0
    v_mov_b32 v65, 0
    v_mov_b32 v66, 0
    v_mov_b32 v67, 0
    v_mov_b32 v68, 0
    v_mov_b32 v69, 0
    v_mov_b32 v70, 0
    v_mov_b32 v71, 0
    v_mov_b32 v72, 0
    v_mov_b32 v73, 0
    v_mov_b32 v74, 0
    v_mov_b32 v75, 0
    v_mov_b32 v76, 0
    v_mov_b32 v77, 0
    v_mov_b32 v78, 0
    v_mov_b32 v79, 0
    s_add_u32 s52, s32, 0x1000000
    s_addc_u32 s53, s33, 0
    s_mov_b32 s54, 0x700000
    s_mov_b32 s55, 0x00020000
    s_mul_i32 s8, s3, 229376
    s_lshl_b32 s9, s6, 10
    s_add_u32 s8, s8, s9
    v_add_u32 v10, s8, v9
    v_add_u32 v12, 57344, v10
    v_add_u32 v13, 57344, v12
    v_add_u32 v14, 57344, v13
    s_lshr_b32 s21, s62, 2
    s_lshr_b32 s22, s63, 2
    s_lshr_b32 s23, s64, 2
    s_lshr_b32 s24, s65, 2
    s_lshr_b32 s25, s66, 2
    s_lshr_b32 s26, s67, 2
    s_waitcnt vmcnt(0) lgkmcnt(0)
    v_mov_b32 v7, 1
    v_mov_b32 v15, 139264
    s_mov_b64 exec, 1
    ds_add_rtn_u32 v7, v15, v7
    s_waitcnt lgkmcnt(0)
    v_readfirstlane_b32 s8, v7
    s_nop 0
    s_cmp_lg_u32 s8, 7
    s_cbranch_scc1 K34_NOSIG
    v_mov_b32 v7, s60
    s_lshl_b32 s8, s2, 7
    s_add_u32 s8, s8, 0x30000
    v_mov_b32 v15, s8
    global_store_dword v15, v7, s[32:33] sc1
K34_NOSIG:
    s_mov_b64 exec, -1
    v_mfma_f32_16x16x32_bf16 v[16:19], v[128:131], v[80:83], v[16:19]
    v_mfma_f32_16x16x32_bf16 v[20:23], v[128:131], v[84:87], v[20:23]
    v_mfma_f32_16x16x32_bf16 v[24:27], v[128:131], v[88:91], v[24:27]
    v_mfma_f32_16x16x32_bf16 v[28:31], v[128:131], v[92:95], v[28:31]
    v_mfma_f32_16x16x32_bf16 v[32:35], v[132:135], v[80:83], v[32:35]
    v_mfma_f32_16x16x32_bf16 v[36:39], v[132:135], v[84:87], v[36:39]
    v_mfma_f32_16x16x32_bf16 v[40:43], v[132:135], v[88:91], v[40:43]
    v_mfma_f32_16x16x32_bf16 v[44:47], v[132:135], v[92:95], v[44:47]
    v_mfma_f32_16x16x32_bf16 v[48:51], v[136:139], v[80:83], v[48:51]
    v_mfma_f32_16x16x32_bf16 v[52:55], v[136:139], v[84:87], v[52:55]
    v_mfma_f32_16x16x32_bf16 v[56:59], v[136:139], v[88:91], v[56:59]
    v_mfma_f32_16x16x32_bf16 v[60:63], v[136:139], v[92:95], v[60:63]
    v_mfma_f32_16x16x32_bf16 v[64:67], v[140:143], v[80:83], v[64:67]
    v_mfma_f32_16x16x32_bf16 v[68:71], v[140:143], v[84:87], v[68:71]
    v_mfma_f32_16x16x32_bf16 v[72:75], v[140:143], v[88:91], v[72:75]
    v_mfma_f32_16x16x32_bf16 v[76:79], v[140:143], v[92:95], v[76:79]
    s_cmp_eq_u32 s6, 0
    s_cbranch_scc1 K34_DOPOLL
    buffer_load_dwordx4 v[208:211], v11, s[48:51], s66 offen offset:0
    buffer_load_dwordx4 v[212:215], v11, s[48:51], s66 offen offset:1024
    buffer_load_dwordx4 v[216:219], v11, s[48:51], s66 offen offset:2048
    buffer_load_dwordx4 v[220:223], v11, s[48:51], s66 offen offset:3072
    buffer_load_dwordx4 v[224:227], v11, s[48:51], s67 offen offset:0
    buffer_load_dwordx4 v[228:231], v11, s[48:51], s67 offen offset:1024
    buffer_load_dwordx4 v[232:235], v11, s[48:51], s67 offen offset:2048
    buffer_load_dwordx4 v[236:239], v11, s[48:51], s67 offen offset:3072
    buffer_load_ushort v240, v5, s[12:15], s34 offen
    buffer_load_ushort v241, v5, s[12:15], s35 offen
    buffer_load_ushort v242, v5, s[12:15], s36 offen
    buffer_load_ushort v243, v5, s[12:15], s37 offen
    buffer_load_ushort v244, v5, s[12:15], s38 offen
    buffer_load_ushort v245, v5, s[12:15], s39 offen
    buffer_load_ushort v246, v5, s[12:15], s40 offen
    buffer_load_ushort v247, v5, s[12:15], s41 offen
    s_branch K34_NOPOLL
K34_DOPOLL:
    s_and_b32 s8, s2, 31
    v_min_u32 v15, 6, v2
    v_lshlrev_b32 v15, 5, v15
    v_add_u32 v15, s8, v15
    v_lshlrev_b32 v15, 7, v15
    v_add_u32 v15, 0x30000, v15
    s_mov_b32 s8, 0
K34_POLL:
    global_load_dword v7, v15, s[32:33] sc1
    s_waitcnt vmcnt(0)
    v_cmp_ne_u32 vcc, s60, v7
    s_add_u32 s8, s8, 1
    s_cbranch_vccz K34_POLLED
    s_sleep 2
    s_cmp_lt_u32 s8, 20000
    s_cbranch_scc1 K34_POLL
K34_POLLED:
    buffer_load_dwordx4 v[208:211], v11, s[48:51], s66 offen offset:0
    buffer_load_dwordx4 v[212:215], v11, s[48:51], s66 offen offset:1024
    buffer_load_dwordx4 v[216:219], v11, s[48:51], s66 offen offset:2048
    buffer_load_dwordx4 v[220:223], v11, s[48:51], s66 offen offset:3072
    buffer_load_dwordx4 v[224:227], v11, s[48:51], s67 offen offset:0
    buffer_load_dwordx4 v[228:231], v11, s[48:51], s67 offen offset:1024
    buffer_load_dwordx4 v[232:235], v11, s[48:51], s67 offen offset:2048
    buffer_load_dwordx4 v[236:239], v11, s[48:51], s67 offen offset:3072
    buffer_load_ushort v240, v5, s[12:15], s34 offen
    buffer_load_ushort v241, v5, s[12:15], s35 offen
    buffer_load_ushort v242, v5, s[12:15], s36 offen
    buffer_load_ushort v243, v5, s[12:15], s37 offen
    buffer_load_ushort v244, v5, s[12:15], s38 offen
    buffer_load_ushort v245, v5, s[12:15], s39 offen
    buffer_load_ushort v246, v5, s[12:15], s40 offen
    buffer_load_ushort v247, v5, s[12:15], s41 offen
K34_NOPOLL:
    s_barrier
    buffer_load_dwordx4 v[96:99], v10, s[52:55], s21 offen sc1
    buffer_load_dwordx4 v[100:103], v12, s[52:55], s21 offen sc1
    buffer_load_dwordx4 v[104:107], v13, s[52:55], s21 offen sc1
    buffer_load_dwordx4 v[108:111], v14, s[52:55], s21 offen sc1
    buffer_load_dwordx4 v[112:115], v10, s[52:55], s22 offen sc1
    buffer_load_dwordx4 v[116:119], v12, s[52:55], s22 offen sc1
    buffer_load_dwordx4 v[120:123], v13, s[52:55], s22 offen sc1
    buffer_load_dwordx4 v[124:127], v14, s[52:55], s22 offen sc1
    buffer_load_dwordx4 v[80:83], v10, s[52:55], s23 offen sc1
    buffer_load_dwordx4 v[84:87], v12, s[52:55], s23 offen sc1
    buffer_load_dwordx4 v[88:91], v13, s[52:55], s23 offen sc1
    buffer_load_dwordx4 v[92:95], v14, s[52:55], s23 offen sc1
    s_waitcnt vmcnt(8)
    v_mfma_f32_16x16x32_bf16 v[16:19], v[144:147], v[96:99], v[16:19]
    v_mfma_f32_16x16x32_bf16 v[20:23], v[144:147], v[100:103], v[20:23]
    v_mfma_f32_16x16x32_bf16 v[24:27], v[144:147], v[104:107], v[24:27]
    v_mfma_f32_16x16x32_bf16 v[28:31], v[144:147], v[108:111], v[28:31]
    v_mfma_f32_16x16x32_bf16 v[32:35], v[148:151], v[96:99], v[32:35]
    v_mfma_f32_16x16x32_bf16 v[36:39], v[148:151], v[100:103], v[36:39]
    v_mfma_f32_16x16x32_bf16 v[40:43], v[148:151], v[104:107], v[40:43]
    v_mfma_f32_16x16x32_bf16 v[44:47], v[148:151], v[108:111], v[44:47]
    v_mfma_f32_16x16x32_bf16 v[48:51], v[152:155], v[96:99], v[48:51]
    v_mfma_f32_16x16x32_bf16 v[52:55], v[152:155], v[100:103], v[52:55]
    v_mfma_f32_16x16x32_bf16 v[56:59], v[152:155], v[104:107], v[56:59]
    v_mfma_f32_16x16x32_bf16 v[60:63], v[152:155], v[108:111], v[60:63]
    v_mfma_f32_16x16x32_bf16 v[64:67], v[156:159], v[96:99], v[64:67]
    v_mfma_f32_16x16x32_bf16 v[68:71], v[156:159], v[100:103], v[68:71]
    v_mfma_f32_16x16x32_bf16 v[72:75], v[156:159], v[104:107], v[72:75]
    v_mfma_f32_16x16x32_bf16 v[76:79], v[156:159], v[108:111], v[76:79]
    buffer_load_dwordx4 v[96:99], v10, s[52:55], s24 offen sc1
    buffer_load_dwordx4 v[100:103], v12, s[52:55], s24 offen sc1
    buffer_load_dwordx4 v[104:107], v13, s[52:55], s24 offen sc1
    buffer_load_dwordx4 v[108:111], v14, s[52:55], s24 offen sc1
    s_waitcnt vmcnt(8)
    v_mfma_f32_16x16x32_bf16 v[16:19], v[160:163], v[112:115], v[16:19]
    v_mfma_f32_16x16x32_bf16 v[20:23], v[160:163], v[116:119], v[20:23]
    v_mfma_f32_16x16x32_bf16 v[24:27], v[160:163], v[120:123], v[24:27]
    v_mfma_f32_16x16x32_bf16 v[28:31], v[160:163], v[124:127], v[28:31]
    v_mfma_f32_16x16x32_bf16 v[32:35], v[164:167], v[112:115], v[32:35]
    v_mfma_f32_16x16x32_bf16 v[36:39], v[164:167], v[116:119], v[36:39]
    v_mfma_f32_16x16x32_bf16 v[40:43], v[164:167], v[120:123], v[40:43]
    v_mfma_f32_16x16x32_bf16 v[44:47], v[164:167], v[124:127], v[44:47]
    v_mfma_f32_16x16x32_bf16 v[48:51], v[168:171], v[112:115], v[48:51]
    v_mfma_f32_16x16x32_bf16 v[52:55], v[168:171], v[116:119], v[52:55]
    v_mfma_f32_16x16x32_bf16 v[56:59], v[168:171], v[120:123], v[56:59]
    v_mfma_f32_16x16x32_bf16 v[60:63], v[168:171], v[124:127], v[60:63]
    v_mfma_f32_16x16x32_bf16 v[64:67], v[172:175], v[112:115], v[64:67]
    v_mfma_f32_16x16x32_bf16 v[68:71], v[172:175], v[116:119], v[68:71]
    v_mfma_f32_16x16x32_bf16 v[72:75], v[172:175], v[120:123], v[72:75]
    v_mfma_f32_16x16x32_bf16 v[76:79], v[172:175], v[124:127], v[76:79]
    buffer_load_dwordx4 v[112:115], v10, s[52:55], s25 offen sc1
    buffer_load_dwordx4 v[116:119], v12, s[52:55], s25 offen sc1
    buffer_load_dwordx4 v[120:123], v13, s[52:55], s25 offen sc1
    buffer_load_dwordx4 v[124:127], v14, s[52:55], s25 offen sc1
    s_waitcnt vmcnt(8)
    v_mfma_f32_16x16x32_bf16 v[16:19], v[176:179], v[80:83], v[16:19]
    v_mfma_f32_16x16x32_bf16 v[20:23], v[176:179], v[84:87], v[20:23]
    v_mfma_f32_16x16x32_bf16 v[24:27], v[176:179], v[88:91], v[24:27]
    v_mfma_f32_16x16x32_bf16 v[28:31], v[176:179], v[92:95], v[28:31]
    v_mfma_f32_16x16x32_bf16 v[32:35], v[180:183], v[80:83], v[32:35]
    v_mfma_f32_16x16x32_bf16 v[36:39], v[180:183], v[84:87], v[36:39]
    v_mfma_f32_16x16x32_bf16 v[40:43], v[180:183], v[88:91], v[40:43]
    v_mfma_f32_16x16x32_bf16 v[44:47], v[180:183], v[92:95], v[44:47]
    v_mfma_f32_16x16x32_bf16 v[48:51], v[184:187], v[80:83], v[48:51]
    v_mfma_f32_16x16x32_bf16 v[52:55], v[184:187], v[84:87], v[52:55]
    v_mfma_f32_16x16x32_bf16 v[56:59], v[184:187], v[88:91], v[56:59]
    v_mfma_f32_16x16x32_bf16 v[60:63], v[184:187], v[92:95], v[60:63]
    v_mfma_f32_16x16x32_bf16 v[64:67], v[188:191], v[80:83], v[64:67]
    v_mfma_f32_16x16x32_bf16 v[68:71], v[188:191], v[84:87], v[68:71]
    v_mfma_f32_16x16x32_bf16 v[72:75], v[188:191], v[88:91], v[72:75]
    v_mfma_f32_16x16x32_bf16 v[76:79], v[188:191], v[92:95], v[76:79]
    buffer_load_dwordx4 v[80:83], v10, s[52:55], s26 offen sc1
    buffer_load_dwordx4 v[84:87], v12, s[52:55], s26 offen sc1
    buffer_load_dwordx4 v[88:91], v13, s[52:55], s26 offen sc1
    buffer_load_dwordx4 v[92:95], v14, s[52:55], s26 offen sc1
    s_waitcnt vmcnt(8)
    v_mfma_f32_16x16x32_bf16 v[16:19], v[192:195], v[96:99], v[16:19]
    v_mfma_f32_16x16x32_bf16 v[20:23], v[192:195], v[100:103], v[20:23]
    v_mfma_f32_16x16x32_bf16 v[24:27], v[192:195], v[104:107], v[24:27]
    v_mfma_f32_16x16x32_bf16 v[28:31], v[192:195], v[108:111], v[28:31]
    v_mfma_f32_16x16x32_bf16 v[32:35], v[196:199], v[96:99], v[32:35]
    v_mfma_f32_16x16x32_bf16 v[36:39], v[196:199], v[100:103], v[36:39]
    v_mfma_f32_16x16x32_bf16 v[40:43], v[196:199], v[104:107], v[40:43]
    v_mfma_f32_16x16x32_bf16 v[44:47], v[196:199], v[108:111], v[44:47]
    v_mfma_f32_16x16x32_bf16 v[48:51], v[200:203], v[96:99], v[48:51]
    v_mfma_f32_16x16x32_bf16 v[52:55], v[200:203], v[100:103], v[52:55]
    v_mfma_f32_16x16x32_bf16 v[56:59], v[200:203], v[104:107], v[56:59]
    v_mfma_f32_16x16x32_bf16 v[60:63], v[200:203], v[108:111], v[60:63]
    v_mfma_f32_16x16x32_bf16 v[64:67], v[204:207], v[96:99], v[64:67]
    v_mfma_f32_16x16x32_bf16 v[68:71], v[204:207], v[100:103], v[68:71]
    v_mfma_f32_16x16x32_bf16 v[72:75], v[204:207], v[104:107], v[72:75]
    v_mfma_f32_16x16x32_bf16 v[76:79], v[204:207], v[108:111], v[76:79]
    s_waitcnt vmcnt(4)
    v_mfma_f32_16x16x32_bf16 v[16:19], v[208:211], v[112:115], v[16:19]
    v_mfma_f32_16x16x32_bf16 v[20:23], v[208:211], v[116:119], v[20:23]
    v_mfma_f32_16x16x32_bf16 v[24:27], v[208:211], v[120:123], v[24:27]
    v_mfma_f32_16x16x32_bf16 v[28:31], v[208:211], v[124:127], v[28:31]
    v_mfma_f32_16x16x32_bf16 v[32:35], v[212:215], v[112:115], v[32:35]
    v_mfma_f32_16x16x32_bf16 v[36:39], v[212:215], v[116:119], v[36:39]
    v_mfma_f32_16x16x32_bf16 v[40:43], v[212:215], v[120:123], v[40:43]
    v_mfma_f32_16x16x32_bf16 v[44:47], v[212:215], v[124:127], v[44:47]
    v_mfma_f32_16x16x32_bf16 v[48:51], v[216:219], v[112:115], v[48:51]
    v_mfma_f32_16x16x32_bf16 v[52:55], v[216:219], v[116:119], v[52:55]
    v_mfma_f32_16x16x32_bf16 v[56:59], v[216:219], v[120:123], v[56:59]
    v_mfma_f32_16x16x32_bf16 v[60:63], v[216:219], v[124:127], v[60:63]
    v_mfma_f32_16x16x32_bf16 v[64:67], v[220:223], v[112:115], v[64:67]
    v_mfma_f32_16x16x32_bf16 v[68:71], v[220:223], v[116:119], v[68:71]
    v_mfma_f32_16x16x32_bf16 v[72:75], v[220:223], v[120:123], v[72:75]
    v_mfma_f32_16x16x32_bf16 v[76:79], v[220:223], v[124:127], v[76:79]
    s_waitcnt vmcnt(0)
    v_mfma_f32_16x16x32_bf16 v[16:19], v[224:227], v[80:83], v[16:19]
    v_mfma_f32_16x16x32_bf16 v[20:23], v[224:227], v[84:87], v[20:23]
    v_mfma_f32_16x16x32_bf16 v[24:27], v[224:227], v[88:91], v[24:27]
    v_mfma_f32_16x16x32_bf16 v[28:31], v[224:227], v[92:95], v[28:31]
    v_mfma_f32_16x16x32_bf16 v[32:35], v[228:231], v[80:83], v[32:35]
    v_mfma_f32_16x16x32_bf16 v[36:39], v[228:231], v[84:87], v[36:39]
    v_mfma_f32_16x16x32_bf16 v[40:43], v[228:231], v[88:91], v[40:43]
    v_mfma_f32_16x16x32_bf16 v[44:47], v[228:231], v[92:95], v[44:47]
    v_mfma_f32_16x16x32_bf16 v[48:51], v[232:235], v[80:83], v[48:51]
    v_mfma_f32_16x16x32_bf16 v[52:55], v[232:235], v[84:87], v[52:55]
    v_mfma_f32_16x16x32_bf16 v[56:59], v[232:235], v[88:91], v[56:59]
    v_mfma_f32_16x16x32_bf16 v[60:63], v[232:235], v[92:95], v[60:63]
    v_mfma_f32_16x16x32_bf16 v[64:67], v[236:239], v[80:83], v[64:67]
    v_mfma_f32_16x16x32_bf16 v[68:71], v[236:239], v[84:87], v[68:71]
    v_mfma_f32_16x16x32_bf16 v[72:75], v[236:239], v[88:91], v[72:75]
    v_mfma_f32_16x16x32_bf16 v[76:79], v[236:239], v[92:95], v[76:79]
    v_and_b32 v6, 15, v2
    v_lshrrev_b32 v7, 4, v2
    s_movk_i32 s8, 272
    v_mul_lo_u32 v6, v6, s8
    v_lshl_add_u32 v6, v7, 4, v6
    s_mul_i32 s9, s6, 17408
    v_add_u32 v6, s9, v6
    ds_write_b128 v6, v[16:19] offset:0
    ds_write_b128 v6, v[20:23] offset:4352
    ds_write_b128 v6, v[24:27] offset:8704
    ds_write_b128 v6, v[28:31] offset:13056
    ds_write_b128 v6, v[32:35] offset:64
    ds_write_b128 v6, v[36:39] offset:4416
    ds_write_b128 v6, v[40:43] offset:8768
    ds_write_b128 v6, v[44:47] offset:13120
    ds_write_b128 v6, v[48:51] offset:128
    ds_write_b128 v6, v[52:55] offset:4480
    ds_write_b128 v6, v[56:59] offset:8832
    ds_write_b128 v6, v[60:63] offset:13184
    ds_write_b128 v6, v[64:67] offset:192
    ds_write_b128 v6, v[68:71] offset:4544
    ds_write_b128 v6, v[72:75] offset:8896
    ds_write_b128 v6, v[76:79] offset:13248
    s_waitcnt lgkmcnt(0)
    s_barrier
    v_mul_lo_u32 v6, v3, s8
    v_lshl_add_u32 v6, v4, 5, v6
    v_add_u32 v7, 69632, v6
    ds_read_b128 v[80:83], v6 offset:0
    ds_read_b128 v[84:87], v6 offset:16
    ds_read_b128 v[88:91], v6 offset:17408
    ds_read_b128 v[92:95], v6 offset:17424
    ds_read_b128 v[96:99], v6 offset:34816
    ds_read_b128 v[100:103], v6 offset:34832
    ds_read_b128 v[104:107], v6 offset:52224
    ds_read_b128 v[108:111], v6 offset:52240
    ds_read_b128 v[112:115], v7 offset:0
    ds_read_b128 v[116:119], v7 offset:16
    ds_read_b128 v[120:123], v7 offset:17408
    ds_read_b128 v[124:127], v7 offset:17424
    ds_read_b128 v[128:131], v7 offset:34816
    ds_read_b128 v[132:135], v7 offset:34832
    ds_read_b128 v[136:139], v7 offset:52224
    ds_read_b128 v[140:143], v7 offset:52240
    s_waitcnt lgkmcnt(0)
    v_add_f32 v80, v80, v88
    v_add_f32 v96, v96, v104
    v_add_f32 v112, v112, v120
    v_add_f32 v128, v128, v136
    v_add_f32 v80, v80, v96
    v_add_f32 v112, v112, v128
    v_add_f32 v80, v80, v112
    v_add_f32 v81, v81, v89
    v_add_f32 v97, v97, v105
    v_add_f32 v113, v113, v121
    v_add_f32 v129, v129, v137
    v_add_f32 v81, v81, v97
    v_add_f32 v113, v113, v129
    v_add_f32 v81, v81, v113
    v_add_f32 v82, v82, v90
    v_add_f32 v98, v98, v106
    v_add_f32 v114, v114, v122
    v_add_f32 v130, v130, v138
    v_add_f32 v82, v82, v98
    v_add_f32 v114, v114, v130
    v_add_f32 v82, v82, v114
    v_add_f32 v83, v83, v91
    v_add_f32 v99, v99, v107
    v_add_f32 v115, v115, v123
    v_add_f32 v131, v131, v139
    v_add_f32 v83, v83, v99
    v_add_f32 v115, v115, v131
    v_add_f32 v83, v83, v115
    v_add_f32 v84, v84, v92
    v_add_f32 v100, v100, v108
    v_add_f32 v116, v116, v124
    v_add_f32 v132, v132, v140
    v_add_f32 v84, v84, v100
    v_add_f32 v116, v116, v132
    v_add_f32 v84, v84, v116
    v_add_f32 v85, v85, v93
    v_add_f32 v101, v101, v109
    v_add_f32 v117, v117, v125
    v_add_f32 v133, v133, v141
    v_add_f32 v85, v85, v101
    v_add_f32 v117, v117, v133
    v_add_f32 v85, v85, v117
    v_add_f32 v86, v86, v94
    v_add_f32 v102, v102, v110
    v_add_f32 v118, v118, v126
    v_add_f32 v134, v134, v142
    v_add_f32 v86, v86, v102
    v_add_f32 v118, v118, v134
    v_add_f32 v86, v86, v118
    v_add_f32 v87, v87, v95
    v_add_f32 v103, v103, v111
    v_add_f32 v119, v119, v127
    v_add_f32 v135, v135, v143
    v_add_f32 v87, v87, v103
    v_add_f32 v119, v119, v135
    v_add_f32 v87, v87, v119
    v_cvt_pk_bf16_f32 v12, v80, v81
    v_lshlrev_b32 v13, 16, v12
    v_and_b32 v14, s44, v12
    v_lshlrev_b32 v240, 16, v240
    v_lshlrev_b32 v241, 16, v241
    v_add_f32 v13, v13, v240
    v_add_f32 v14, v14, v241
    v_cvt_pk_bf16_f32 v16, v13, v14
    v_cvt_pk_bf16_f32 v12, v82, v83
    v_lshlrev_b32 v13, 16, v12
    v_and_b32 v14, s44, v12
    v_lshlrev_b32 v242, 16, v242
    v_lshlrev_b32 v243, 16, v243
    v_add_f32 v13, v13, v242
    v_add_f32 v14, v14, v243
    v_cvt_pk_bf16_f32 v17, v13, v14
    v_cvt_pk_bf16_f32 v12, v84, v85
    v_lshlrev_b32 v13, 16, v12
    v_and_b32 v14, s44, v12
    v_lshlrev_b32 v244, 16, v244
    v_lshlrev_b32 v245, 16, v245
    v_add_f32 v13, v13, v244
    v_add_f32 v14, v14, v245
    v_cvt_pk_bf16_f32 v18, v13, v14
    v_cvt_pk_bf16_f32 v12, v86, v87
    v_lshlrev_b32 v13, 16, v12
    v_and_b32 v14, s44, v12
    v_lshlrev_b32 v246, 16, v246
    v_lshlrev_b32 v247, 16, v247
    v_add_f32 v13, v13, v246
    v_add_f32 v14, v14, v247
    v_cvt_pk_bf16_f32 v19, v13, v14
    s_lshl_b32 s8, s3, 6
    v_add_u32 v5, s8, v3
    s_movk_i32 s9, 896
    v_mul_lo_u32 v5, v5, s9
    v_lshl_add_u32 v5, v4, 4, v5
    s_lshl_b32 s8, s4, 7
    v_add_u32 v5, s8, v5
    global_store_dwordx4 v5, v[16:19], s[30:31] sc1
    s_endpgm
K34_PF:
    s_sub_u32 s3, s2, 224
    s_lshr_b32 s3, s3, 3
    s_mul_i32 s3, s3, 401408
    v_lshlrev_b32 v1, 4, v0
    v_add_u32 v1, s3, v1
    s_waitcnt lgkmcnt(0)
    s_add_u32 s12, s32, 0xc00000
    s_addc_u32 s13, s33, 0
    s_mov_b32 s14, 0x188000
    s_mov_b32 s15, 0x00020000
    s_mov_b32 s4, 0
K34_PFL:
    buffer_load_dwordx4 v[8:11], v1, s[12:15], s4 offen
    s_add_u32 s4, s4, 8192
    buffer_load_dwordx4 v[12:15], v1, s[12:15], s4 offen
    s_add_u32 s4, s4, 8192
    buffer_load_dwordx4 v[16:19], v1, s[12:15], s4 offen
    s_add_u32 s4, s4, 8192
    buffer_load_dwordx4 v[20:23], v1, s[12:15], s4 offen
    s_add_u32 s4, s4, 8192
    buffer_load_dwordx4 v[24:27], v1, s[12:15], s4 offen
    s_add_u32 s4, s4, 8192
    buffer_load_dwordx4 v[28:31], v1, s[12:15], s4 offen
    s_add_u32 s4, s4, 8192
    buffer_load_dwordx4 v[32:35], v1, s[12:15], s4 offen
    s_add_u32 s4, s4, 8192
    s_waitcnt vmcnt(0)
    s_cmp_lt_u32 s4, 401408
    s_cbranch_scc1 K34_PFL
K34_END:
    s_endpgm
CODE_END:
.section .rodata,"a"
.p2align 6
.amdhsa_kernel k12_kernel
  .amdhsa_next_free_vgpr 232
  .amdhsa_next_free_sgpr 102
  .amdhsa_accum_offset 232
  .amdhsa_group_segment_fixed_size 0
  .amdhsa_kernarg_size 120
  .amdhsa_user_sgpr_count 2
  .amdhsa_user_sgpr_kernarg_segment_ptr 1
  .amdhsa_system_sgpr_workgroup_id_x 1
  .amdhsa_float_denorm_mode_32 3
.end_amdhsa_kernel
.p2align 6
.amdhsa_kernel k34_kernel
  .amdhsa_next_free_vgpr 252
  .amdhsa_next_free_sgpr 102
  .amdhsa_accum_offset 252
  .amdhsa_group_segment_fixed_size 0
  .amdhsa_kernarg_size 120
  .amdhsa_user_sgpr_count 2
  .amdhsa_user_sgpr_kernarg_segment_ptr 1
  .amdhsa_system_sgpr_workgroup_id_x 1
  .amdhsa_float_denorm_mode_32 3
.end_amdhsa_kernel
```
